```python
import torch

def _softmax(x, axis=-1):
    return torch.softmax(x, dim=axis)
def _gelu(x):
    return torch.nn.functional.gelu(x, approximate="tanh")
def _silu(x):
    return torch.nn.functional.silu(x)
def _sigmoid(x):
    return torch.sigmoid(x)
def _layernorm(x, axis=-1, eps=1e-5):
    m = x.mean(dim=axis, keepdim=True)
    v = x.var(dim=axis, keepdim=True, unbiased=False)
    return (x - m) / torch.sqrt(v + eps)
def _scatter_add(tgt, idx, src, axis=0):
    return tgt.clone().index_add_(axis, idx, src)
def _segment_sum(src, seg, n):
    out = torch.zeros((n,) + src.shape[1:], dtype=src.dtype)
    return out.index_add_(0, seg, src)
def _pad(x, pw):
    flat = tuple(v for pair in reversed(pw) for v in pair)
    return torch.nn.functional.pad(x, flat)

kernel_name = 'concat_heads__sliding_block_cached__compressed_kv_cla__decode'

def setup_inputs():

    _w = (lambda a: (lambda t: t.to(torch.bfloat16) if t.is_floating_point() else t)(torch.as_tensor(a)))
    def _A_setup():
        B, Sq, D = 4, 1, 512
        Hq, Hkv, Sk, Dh = 32, 8, 4096, 128
        assert Hq % Hkv == 0, (Hq, Hkv)
        return {
            "x": _w((lambda *s: torch.randn(*s, dtype=torch.bfloat16) * 0.8)(B, Sq, D)),
            "k_cache": _w((lambda *s: torch.randn(*s, dtype=torch.bfloat16) * 0.8)(B, Hkv, Sk, Dh)),
            "v_cache": _w((lambda *s: torch.randn(*s, dtype=torch.bfloat16) * 0.05)(B, Hkv, Sk, Dh)),
            "wq": _w((lambda *s: torch.randn(*s, dtype=torch.bfloat16) * 0.8)(D, Hq * Dh) * (D ** -0.5)),
            "wo": _w((lambda *s: torch.randn(*s, dtype=torch.bfloat16) * 0.05)(Hq * Dh, D) * ((Hq * Dh) ** -0.5)),
        }
    _A_in = _A_setup()

    def _B_setup():
        B, H, Sq, Sk, D, M = 4, 32, 1, 4096, 128, 512
        Dc = 4 * D
        return {
            "x": _w((lambda *s: torch.randn(*s, dtype=torch.bfloat16) * 1.6)(B, Sq, M)),
            "c_kv": _w((lambda *s: torch.randn(*s, dtype=torch.bfloat16) * 0.1)(B, Sk, Dc)),
            "w_q": _w((lambda *s: torch.randn(*s, dtype=torch.bfloat16) * 3.2)(M, H, D) * (M ** -0.5)),
            "w_uk": _w((lambda *s: torch.randn(*s, dtype=torch.bfloat16) * 3.2)(Dc, H, D) * (Dc ** -0.5)),
            "w_uv": _w((lambda *s: torch.randn(*s, dtype=torch.bfloat16) * 0.1)(Dc, H, D) * (Dc ** -0.5)),
            "w_o": _w((lambda *s: torch.randn(*s, dtype=torch.bfloat16) * 0.1)(H, D, M) * ((H * D) ** -0.5)),
        }
    _B_in = _B_setup()

    return {
        "A_x": _A_in["x"],
        "A_k_cache": _A_in["k_cache"],
        "A_v_cache": _A_in["v_cache"],
        "A_wq": _A_in["wq"],
        "A_wo": _A_in["wo"],
        "B_x": _B_in["x"],
        "B_c_kv": _B_in["c_kv"],
        "B_w_q": _B_in["w_q"],
        "B_w_uk": _B_in["w_uk"],
        "B_w_uv": _B_in["w_uv"],
        "B_w_o": _B_in["w_o"],
    }

def reference(A_x, A_k_cache, A_v_cache, A_wq, A_wo, B_x, B_c_kv, B_w_q, B_w_uk, B_w_uv, B_w_o):
    def _A_ref(x, k_cache, v_cache, wq, wo):
        B, Sq, D = x.shape
        Hq, Dh = 32, 128
        Hkv, Sk = k_cache.shape[1], k_cache.shape[2]
        W = min(4096, max(256, Sk // 4))
        rep = Hq // Hkv
        q = (lambda x, *d: x.permute(*d))((x @ wq).reshape(B, Sq, Hq, Dh), 0, 2, 1, 3)
        k = (lambda x, n, axis: torch.repeat_interleave(x, n, dim=axis))(k_cache[:, :, Sk - W:, :], rep, axis=1)
        v = (lambda x, n, axis: torch.repeat_interleave(x, n, dim=axis))(v_cache[:, :, Sk - W:, :], rep, axis=1)
        scores = torch.einsum("bhqd,bhkd->bhqk", q, k) * (Dh ** -0.5)
        p = _softmax(scores, axis=-1)
        o = torch.einsum("bhqk,bhkd->bhqd", p, v)
        return (lambda x, *d: x.permute(*d))(o, 0, 2, 1, 3).reshape(B, Sq, Hq * Dh) @ wo

    def _B_ref(x, c_kv, w_q, w_uk, w_uv, w_o):
        B, Sq, M = x.shape[0], x.shape[1], x.shape[2]
        Sk = c_kv.shape[1]
        H, D = w_q.shape[1], w_q.shape[2]
        q = torch.einsum("bqm,mhd->bhqd", x, w_q)
        k = torch.einsum("bkc,chd->bhkd", c_kv, w_uk)
        v = torch.einsum("bkc,chd->bhkd", c_kv, w_uv)
        scores = torch.einsum("bhqd,bhkd->bhqk", q, k) * (D ** -0.5)
        off = Sk - Sq
        qi = torch.arange(Sq)[:, None]
        kj = torch.arange(Sk)[None, :]
        cmask = kj <= (qi + off)
        scores = torch.where(cmask[None, None], scores, -1e9)
        p = _softmax(scores, axis=-1)
        ctx = torch.einsum("bhqk,bhkd->bhqd", p, v)
        return torch.einsum("bhqd,hdm->bqm", ctx, w_o)

    a = _A_ref(A_x, A_k_cache, A_v_cache, A_wq, A_wo)
    b = _B_ref(B_x, B_c_kv, B_w_q, B_w_uk, B_w_uv, B_w_o)
    return torch.concatenate([a, b], axis=-1)
```

```asm
; @launch grid=(256,1,1) block=(512,1,1) lds=163840
.amdgcn_target "amdgcn-amd-amdhsa--gfx950"
.text
.globl concat_heads__sliding_block_cached__compressed_kv_cla__decode_kernel
.p2align 8
.type concat_heads__sliding_block_cached__compressed_kv_cla__decode_kernel,@function
concat_heads__sliding_block_cached__compressed_kv_cla__decode_kernel:

    s_load_dwordx16 s[76:91], s[0:1], 48
    s_cmpk_ge_u32 s2, 256
    s_cbranch_scc1 L_exit
    v_readfirstlane_b32 s3, v0
    s_and_b32 s4, s2, 7
    s_bfe_u32 s5, s2, 0x40003
    s_lshl4_add_u32 s4, s4, s5
    s_lshr_b32 s3, s3, 6
    s_bitcmp1_b32 s2, 7
    s_cbranch_scc0 L_A
    s_cmp_ge_u32 s3, 4
    s_cbranch_scc1 L_BP
    v_and_b32 v0, 63, v0
    s_lshl_b32 m0, s3, 15
    s_lshl_b32 s25, s4, 17
    s_add_u32 s25, s25, m0
    v_lshl_add_u32 v20, v0, 4, s25
    v_xor_b32 v21, 32, v20
    s_waitcnt lgkmcnt(0)
    global_load_lds_dwordx4 v20, s[76:77] offset:0 nt
    global_load_lds_dwordx4 v21, s[76:77] offset:1024 nt
    s_branch L_B
L_A:
    s_cmp_ge_u32 s3, 4
    s_cbranch_scc1 L_T4
    s_mul_i32 s27, s4, 0x100040
    s_and_b32 s27, s27, 0x301f00
    v_mul_u32_u24 v9, 0x1010, v0
    v_and_b32 v9, 0xf00f0, v9
    v_add_u32 v9, s27, v9
    s_movk_i32 s29, 0x2000
    s_waitcnt lgkmcnt(0)
    global_load_dwordx4 v[32:35], v9, s[78:79] nt
    v_add_u32 v9, s29, v9
    global_load_dwordx4 v[36:39], v9, s[78:79] nt
    v_add_u32 v9, s29, v9
    global_load_dwordx4 v[40:43], v9, s[78:79] nt
    v_add_u32 v9, s29, v9
    global_load_dwordx4 v[44:47], v9, s[78:79] nt
    v_add_u32 v9, s29, v9
    global_load_dwordx4 v[48:51], v9, s[78:79] nt
    v_add_u32 v9, s29, v9
    global_load_dwordx4 v[52:55], v9, s[78:79] nt
    v_add_u32 v9, s29, v9
    global_load_dwordx4 v[56:59], v9, s[78:79] nt
    v_add_u32 v9, s29, v9
    global_load_dwordx4 v[60:63], v9, s[78:79] nt
    s_branch L_A1
    .if . - concat_heads__sliding_block_cached__compressed_kv_cla__decode_kernel > 256
    .error "prologue too long"
    .endif
    .p2align 8
L_T4:
    s_load_dwordx8 s[64:71], s[0:1], 0
    s_load_dwordx4 s[72:75], s[0:1], 32
    v_and_b32 v0, 63, v0
    s_lshr_b32 s5, s4, 2
    s_and_b32 s6, s4, 3
    s_mov_b32 s14, 0x10000000
    s_mov_b32 s15, 0x20000
    s_and_b32 s28, s3, 3

    v_and_b32 v10, 15, v0
    v_lshlrev_b32 v10, 7, v10
    v_lshrrev_b32 v4, 4, v0
    v_lshl_add_u32 v10, v4, 18, v10
    s_lshl_b32 s99, s4, 11
    s_add_u32 s99, s99, 0x40000
    s_cmp_eq_u32 s28, 0
    s_cselect_b32 exec_lo, -1, 0
    s_mov_b32 exec_hi, 0
    s_waitcnt lgkmcnt(0)
    s_mov_b64 s[12:13], s[90:91]
    buffer_load_dword v12, v10, s[12:15], s99 offen sc1
    s_mov_b64 exec, -1

    s_cmp_eq_u32 s28, 2
    s_cbranch_scc0 Lxt_3
    s_getreg_b32 s95, hwreg(HW_REG_XCC_ID, 0, 4)
    s_and_b32 s92, s2, 7
    s_lshl_b32 s92, s92, 5
    s_lshr_b32 s93, s2, 3
    s_add_u32 s92, s92, s93
    s_add_u32 s95, s95, 1
    v_mov_b32 v16, s92
    v_mov_b32 v17, s95
    s_mov_b64 exec, 1
    global_store_byte v16, v17, s[88:89]
    global_load_ubyte v18, v16, s[88:89] sc1
    s_mov_b64 exec, -1
Lxt_3:
    s_load_dword s24, s[12:13], 0x0
    s_barrier
    s_branch L_T4b
L_A1:
    v_and_b32 v8, 0xf0, v0
    s_load_dwordx8 s[64:71], s[0:1], 0
    s_load_dwordx4 s[72:75], s[0:1], 32
    v_and_b32 v0, 63, v0
    s_lshr_b32 s5, s4, 2
    s_and_b32 s6, s4, 3
    s_mov_b32 s14, 0x10000000
    s_mov_b32 s15, 0x20000
    s_and_b32 s28, s3, 3

    v_lshrrev_b32 v12, 4, v0
    v_and_b32 v13, 15, v0
    v_lshlrev_b32 v1, 18, v12
    v_lshl_add_u32 v1, v13, 4, v1
    v_lshrrev_b32 v14, 2, v13
    v_lshlrev_b32 v2, 6, v12
    v_lshl_add_u32 v2, v14, 10, v2

    s_lshl_b32 s25, s3, 16
    s_add_u32 s25, s25, s27
    s_lshl_b32 s26, s6, 8
    v_lshl_add_u32 v8, v14, 10, v8
    v_add_u32 v8, s26, v8
    s_lshl_b32 s29, s3, 4
    s_add_u32 s26, s26, s29
    s_mov_b32 s18, 0x400000
    s_mov_b32 s19, 0x20000
    s_movk_i32 s22, 0x1000
    s_mov_b32 s23, 0x20000
    s_movk_i32 s29, 0x2000

    s_waitcnt lgkmcnt(0)
    global_load_dwordx4 v[16:19], v8, s[74:75]
    s_mov_b64 s[12:13], s[90:91]
    s_load_dword s24, s[12:13], 0x0

    v_and_b32 v15, 3, v0
    v_lshlrev_b32 v15, 4, v15
    v_lshl_add_u32 v7, v12, 6, v15
    v_lshl_add_u32 v4, v14, 16, v7
    s_lshl_b32 s92, s3, 18
    s_add_u32 s27, s27, s92

    s_xor_b32 s27, s27, 0x200
    s_mov_b32 s16, s80
    s_mov_b32 s17, s81
    s_barrier
    buffer_load_dwordx4 v[128:131], v4, s[16:19], s27 offen nt
    s_add_u32 s27, s27, s29
    buffer_load_dwordx4 v[132:135], v4, s[16:19], s27 offen nt
    s_add_u32 s27, s27, s29
    buffer_load_dwordx4 v[136:139], v4, s[16:19], s27 offen nt
    s_add_u32 s27, s27, s29
    buffer_load_dwordx4 v[140:143], v4, s[16:19], s27 offen nt
    s_add_u32 s27, s27, s29
    buffer_load_dwordx4 v[144:147], v4, s[16:19], s27 offen nt
    s_add_u32 s27, s27, s29
    buffer_load_dwordx4 v[148:151], v4, s[16:19], s27 offen nt
    s_add_u32 s27, s27, s29
    buffer_load_dwordx4 v[152:155], v4, s[16:19], s27 offen nt
    s_add_u32 s27, s27, s29
    buffer_load_dwordx4 v[156:159], v4, s[16:19], s27 offen nt
    s_mov_b32 s30, 0x05040100
    s_mov_b32 s31, 0x07060302

    v_lshl_add_u32 v7, v14, 8, v7
    v_lshlrev_b32 v5, 4, v0
    s_lshl_b32 s92, s3, 11
    s_add_u32 s92, s92, 0x1000
    v_add_u32 v3, s92, v5
    s_lshl_b32 s92, s3, 6
    v_lshl_add_u32 v6, v14, 8, v15
    v_lshl_add_u32 v6, v12, 2, v6
    v_add_u32 v6, s92, v6
    v_lshlrev_b32 v10, 4, v12
    v_lshl_add_u32 v10, v14, 8, v10
    v_add_u32 v10, s92, v10
    v_lshrrev_b32 v11, 2, v0
    v_lshlrev_b32 v11, 4, v11
    v_mov_b32 v20, 1.0
    s_mov_b32 s95, 0x200000
    s_mov_b32 s94, 1

    s_lshl_b32 s99, s5, 13
    s_lshl_b32 s93, s3, 11
    s_add_u32 s99, s99, s93
    s_add_u32 s99, s99, 0x40000
    s_xor_b32 s99, s99, 0x4000
    s_mov_b32 s16, s70
    s_mov_b32 s17, s71
    s_mov_b32 s20, s64
    s_mov_b32 s21, s65
    s_xor_b32 s25, s25, 0x100
    s_waitcnt lgkmcnt(0)
    s_add_u32 s24, s24, 0x01010101
    s_and_b32 s8, s24, 0xff
    s_bfe_u32 s9, s24, 0x80008
    s_bfe_u32 s10, s24, 0x80010
    s_lshr_b32 s11, s24, 24
L_GEMV:
    s_waitcnt vmcnt(15)
    v_perm_b32 v64, v36, v32, s30
    v_perm_b32 v68, v36, v32, s31
    v_perm_b32 v72, v37, v33, s30
    v_perm_b32 v76, v37, v33, s31
    v_perm_b32 v80, v38, v34, s30
    v_perm_b32 v84, v38, v34, s31
    v_perm_b32 v88, v39, v35, s30
    v_perm_b32 v92, v39, v35, s31
    s_waitcnt vmcnt(13)
    v_perm_b32 v65, v44, v40, s30
    v_perm_b32 v69, v44, v40, s31
    v_perm_b32 v73, v45, v41, s30
    v_perm_b32 v77, v45, v41, s31
    v_perm_b32 v81, v46, v42, s30
    v_perm_b32 v85, v46, v42, s31
    v_perm_b32 v89, v47, v43, s30
    v_perm_b32 v93, v47, v43, s31
    s_waitcnt vmcnt(11)
    v_perm_b32 v66, v52, v48, s30
    v_perm_b32 v70, v52, v48, s31
    v_perm_b32 v74, v53, v49, s30
    v_perm_b32 v78, v53, v49, s31
    v_perm_b32 v82, v54, v50, s30
    v_perm_b32 v86, v54, v50, s31
    v_perm_b32 v90, v55, v51, s30
    v_perm_b32 v94, v55, v51, s31
    s_waitcnt vmcnt(8)
    v_perm_b32 v67, v60, v56, s30
    v_perm_b32 v71, v60, v56, s31
    v_perm_b32 v75, v61, v57, s30
    v_mfma_f32_16x16x32_bf16 v[160:163], v[16:19], v[64:67], 0
    v_perm_b32 v79, v61, v57, s31
    v_mfma_f32_16x16x32_bf16 v[164:167], v[16:19], v[68:71], 0
    v_perm_b32 v83, v62, v58, s30
    v_mfma_f32_16x16x32_bf16 v[168:171], v[16:19], v[72:75], 0
    v_perm_b32 v87, v62, v58, s31
    v_mfma_f32_16x16x32_bf16 v[172:175], v[16:19], v[76:79], 0
    s_nop 1
    v_mov_b32 v96, v160
    v_perm_b32 v91, v63, v59, s30
    v_mfma_f32_16x16x32_bf16 v[176:179], v[16:19], v[80:83], 0
    v_mov_b32 v97, v164
    v_perm_b32 v95, v63, v59, s31
    v_mfma_f32_16x16x32_bf16 v[180:183], v[16:19], v[84:87], 0
    v_mov_b32 v98, v168
    v_mfma_f32_16x16x32_bf16 v[184:187], v[16:19], v[88:91], 0
    v_mov_b32 v99, v172
    ds_write_b128 v3, v[96:99]
    v_mfma_f32_16x16x32_bf16 v[188:191], v[16:19], v[92:95], 0
    v_mov_b32 v100, v176
    s_nop 1
    v_mov_b32 v101, v180
    s_nop 0
    v_mov_b32 v102, v184
    s_nop 1
    v_mov_b32 v103, v188
    ds_write_b128 v3, v[100:103] offset:1024
L_CON:
    s_mov_b32 s7, 0
    s_mov_b32 s27, s99
    s_waitcnt lgkmcnt(0)
    s_barrier
    s_barrier

    buffer_load_dwordx4 v[96:99], v5, s[12:15], s27 offen sc1
    buffer_load_dwordx4 v[100:103], v5, s[12:15], s27 offen offset:1024 sc1
    s_branch L_Xc
L_Xp:
    s_add_u32 s7, s7, 1
    s_cmp_lt_u32 s7, 20000
    s_cbranch_scc0 L_Xd
    s_and_b32 s92, s7, 7
    s_cmp_eq_u32 s92, 7
    s_cselect_b32 s92, s95, 0
    s_add_u32 s27, s99, s92
    s_mov_b64 exec, vcc
    buffer_load_dwordx4 v[96:99], v5, s[12:15], s27 offen sc1
    buffer_load_dwordx4 v[100:103], v5, s[12:15], s27 offen offset:1024 sc1
L_Xc:
    s_waitcnt vmcnt(1)
    v_xor_b32 v96, s8, v96
    v_xor_b32 v97, s9, v97
    v_xor_b32 v98, s10, v98
    v_xor_b32 v99, s11, v99
    v_or_b32 v8, v96, v97
    v_or3_b32 v8, v8, v98, v99
    s_waitcnt vmcnt(0)
    v_xor_b32 v100, s8, v100
    v_xor_b32 v101, s9, v101
    v_xor_b32 v102, s10, v102
    v_xor_b32 v103, s11, v103
    v_or3_b32 v8, v8, v100, v101
    v_or3_b32 v8, v8, v102, v103
    v_cmp_ne_u32_sdwa vcc, v8, 0 src0_sel:BYTE_0 src1_sel:DWORD
    s_mov_b64 exec, -1
    s_cbranch_vccnz L_Xp
L_Xd:
    v_permlane32_swap_b32 v96, v100
    v_permlane32_swap_b32 v97, v101
    v_permlane32_swap_b32 v98, v102
    v_permlane32_swap_b32 v99, v103
    v_pk_add_f32 v[96:97], v[96:97], v[100:101]
    v_pk_add_f32 v[98:99], v[98:99], v[102:103]
    s_nop 1
    v_permlane16_swap_b32 v96, v98
    v_permlane16_swap_b32 v97, v99
    v_pk_add_f32 v[96:97], v[96:97], v[98:99]
    v_cvt_pk_bf16_f32 v96, v96, v97

    ds_write_b32 v6, v96
    s_cmp_eq_u32 s94, 2
    s_waitcnt lgkmcnt(0)
    s_barrier
    s_cbranch_scc1 L_P3
    ds_read_b128 v[24:27], v7
    s_mov_b32 s92, 0x10000

    buffer_load_dwordx4 v[16:19], v2, s[20:23], s26 offen
    buffer_load_dwordx4 v[32:35], v1, s[16:19], s25 offen nt
    s_add_u32 s25, s25, s29
    buffer_load_dwordx4 v[36:39], v1, s[16:19], s25 offen nt
    s_add_u32 s25, s25, s29
    buffer_load_dwordx4 v[40:43], v1, s[16:19], s25 offen nt
    s_add_u32 s25, s25, s29
    s_waitcnt lgkmcnt(0)
    v_mfma_f32_16x16x32_bf16 v[160:163], v[128:131], v[24:27], 0
    v_mfma_f32_16x16x32_bf16 v[164:167], v[132:135], v[24:27], 0
    v_mfma_f32_16x16x32_bf16 v[168:171], v[136:139], v[24:27], 0
    v_mfma_f32_16x16x32_bf16 v[172:175], v[140:143], v[24:27], 0
    v_mfma_f32_16x16x32_bf16 v[176:179], v[144:147], v[24:27], 0
    v_mfma_f32_16x16x32_bf16 v[180:183], v[148:151], v[24:27], 0
    v_mfma_f32_16x16x32_bf16 v[184:187], v[152:155], v[24:27], 0
    v_mfma_f32_16x16x32_bf16 v[188:191], v[156:159], v[24:27], 0
    s_nop 0
    v_add_f32_dpp v192, v161, v160 quad_perm:[1,1,1,1] row_mask:0xf bank_mask:0xf
    v_add_f32_dpp v193, v165, v164 quad_perm:[1,1,1,1] row_mask:0xf bank_mask:0xf
    v_add_f32_dpp v194, v169, v168 quad_perm:[1,1,1,1] row_mask:0xf bank_mask:0xf
    v_add_f32_dpp v195, v173, v172 quad_perm:[1,1,1,1] row_mask:0xf bank_mask:0xf
    v_add_f32_dpp v196, v177, v176 quad_perm:[1,1,1,1] row_mask:0xf bank_mask:0xf
    v_add_f32_dpp v197, v181, v180 quad_perm:[1,1,1,1] row_mask:0xf bank_mask:0xf
    v_add_f32_dpp v198, v185, v184 quad_perm:[1,1,1,1] row_mask:0xf bank_mask:0xf
    v_add_f32_dpp v199, v189, v188 quad_perm:[1,1,1,1] row_mask:0xf bank_mask:0xf
    v_add_f32_dpp v192, v162, v192 quad_perm:[2,2,2,2] row_mask:0xf bank_mask:0xf
    v_add_f32_dpp v193, v166, v193 quad_perm:[2,2,2,2] row_mask:0xf bank_mask:0xf
    v_add_f32_dpp v194, v170, v194 quad_perm:[2,2,2,2] row_mask:0xf bank_mask:0xf
    v_add_f32_dpp v195, v174, v195 quad_perm:[2,2,2,2] row_mask:0xf bank_mask:0xf
    v_add_f32_dpp v196, v178, v196 quad_perm:[2,2,2,2] row_mask:0xf bank_mask:0xf
    v_add_f32_dpp v197, v182, v197 quad_perm:[2,2,2,2] row_mask:0xf bank_mask:0xf
    v_add_f32_dpp v198, v186, v198 quad_perm:[2,2,2,2] row_mask:0xf bank_mask:0xf
    v_add_f32_dpp v199, v190, v199 quad_perm:[2,2,2,2] row_mask:0xf bank_mask:0xf
    v_add_f32_dpp v192, v163, v192 quad_perm:[3,3,3,3] row_mask:0xf bank_mask:0xf
    v_add_f32_dpp v193, v167, v193 quad_perm:[3,3,3,3] row_mask:0xf bank_mask:0xf
    v_add_f32_dpp v194, v171, v194 quad_perm:[3,3,3,3] row_mask:0xf bank_mask:0xf
    v_add_f32_dpp v195, v175, v195 quad_perm:[3,3,3,3] row_mask:0xf bank_mask:0xf
    v_add_f32_dpp v196, v179, v196 quad_perm:[3,3,3,3] row_mask:0xf bank_mask:0xf
    v_add_f32_dpp v197, v183, v197 quad_perm:[3,3,3,3] row_mask:0xf bank_mask:0xf
    v_add_f32_dpp v198, v187, v198 quad_perm:[3,3,3,3] row_mask:0xf bank_mask:0xf
    v_add_f32_dpp v199, v191, v199 quad_perm:[3,3,3,3] row_mask:0xf bank_mask:0xf
    v_add_u32 v192, s92, v192
    v_add_u32 v193, s92, v193
    v_perm_b32 v200, v193, v192, s31
    v_add_u32 v194, s92, v194
    v_add_u32 v195, s92, v195
    v_perm_b32 v201, v195, v194, s31
    v_add_u32 v196, s92, v196
    v_add_u32 v197, s92, v197
    v_perm_b32 v202, v197, v196, s31
    v_add_u32 v198, s92, v198
    v_add_u32 v199, s92, v199
    v_perm_b32 v203, v199, v198, s31

    s_mov_b32 exec_lo, 0x11111111
    s_mov_b32 exec_hi, 0x11111111
    ds_write_b128 v10, v[200:203] offset:1024
    s_mov_b64 exec, -1
    s_waitcnt lgkmcnt(0)
    s_barrier

    s_barrier
    buffer_load_dwordx4 v[44:47], v1, s[16:19], s25 offen nt
    s_add_u32 s25, s25, s29
    buffer_load_dwordx4 v[48:51], v1, s[16:19], s25 offen nt
    s_add_u32 s25, s25, s29
    buffer_load_dwordx4 v[52:55], v1, s[16:19], s25 offen nt
    s_add_u32 s25, s25, s29
    buffer_load_dwordx4 v[56:59], v1, s[16:19], s25 offen nt
    s_add_u32 s25, s25, s29
    buffer_load_dwordx4 v[60:63], v1, s[16:19], s25 offen nt
    s_and_b32 s92, s2, 7
    s_lshl_b32 s92, s92, 5

    v_and_b32 v22, 7, v0
    v_lshl_add_u32 v22, v22, 2, s92
    global_load_dword v22, v22, s[88:89] sc1

    v_add_u32 v3, 0x2000, v3
    v_lshl_add_u32 v5, v14, 11, v15
    v_lshl_add_u32 v5, v12, 8, v5
    v_lshlrev_b32 v6, 4, v13
    v_lshl_add_u32 v6, v12, 2, v6
    s_lshl_b32 s92, s3, 8
    v_add_u32 v6, s92, v6
    s_lshr_b32 s26, s4, 4
    s_bfe_u32 s27, s4, 0x20002
    s_mov_b32 s94, 2

    s_lshl_b32 s99, s26, 15
    s_lshl_b32 s93, s3, 13
    s_add_u32 s99, s99, s93
    s_lshl_b32 s93, s27, 6
    s_add_u32 s99, s99, s93
    s_add_u32 s99, s99, 0x80000
    s_waitcnt vmcnt(0)
    s_getreg_b32 s95, hwreg(HW_REG_XCC_ID, 0, 4)
    s_add_u32 s95, s95, 1
    s_mul_i32 s95, s95, 0x01010101
    v_cmp_ne_u32 vcc, s95, v22
    s_nop 1
    s_cmp_eq_u64 vcc, 0
    s_cselect_b32 s95, 0, 0x200000
    s_branch L_GEMV
L_P3:
    s_mov_b32 s16, s72
    s_mov_b32 s17, s73

    v_lshlrev_b32 v1, 4, v13
    v_lshl_add_u32 v1, v12, 11, v1

    s_and_b32 s92, s5, 3
    s_andn2_b32 s5, s5, 3
    s_or_b32 s5, s5, s6
    s_xor_b32 s6, s92, 0
    s_lshl_b32 s25, s5, 17
    s_lshl_b32 s93, s3, 15
    s_add_u32 s25, s25, s93
    s_lshl_b32 s93, s6, 8
    s_add_u32 s25, s25, s93
    s_lshr_b32 s92, s4, 4
    v_and_b32 v22, 7, v0
    v_lshlrev_b32 v22, 7, v22
    s_lshl_b32 s100, s92, 12
    s_lshl_b32 s93, s3, 10
    s_add_u32 s100, s100, s93
    s_add_u32 s100, s100, 0x2000
    buffer_load_dword v21, v22, s[12:15], s100 offen sc1
    buffer_load_dwordx4 v[32:35], v1, s[16:19], s25 offen offset:0 nt
    buffer_load_dwordx4 v[36:39], v1, s[16:19], s25 offen offset:1024 nt
    s_add_u32 s25, s25, 0x2000
    buffer_load_dwordx4 v[40:43], v1, s[16:19], s25 offen offset:0 nt
    buffer_load_dwordx4 v[44:47], v1, s[16:19], s25 offen offset:1024 nt
    s_add_u32 s25, s25, 0x2000
    v_lshlrev_b32 v5, 4, v0
    s_mov_b32 s94, 3
    s_lshl_b32 s99, s5, 13
    s_lshl_b32 s93, s3, 11
    s_add_u32 s99, s99, s93
    s_add_u32 s99, s99, 0xc0000
    s_lshl_b32 s98, s5, 8
    s_add_u32 s98, s98, 0xc000
    s_barrier
    buffer_load_dwordx4 v[48:51], v1, s[16:19], s25 offen offset:0 nt
    buffer_load_dwordx4 v[52:55], v1, s[16:19], s25 offen offset:1024 nt
    s_add_u32 s25, s25, 0x2000
    buffer_load_dwordx4 v[56:59], v1, s[16:19], s25 offen offset:0 nt
    buffer_load_dwordx4 v[60:63], v1, s[16:19], s25 offen offset:1024 nt
    s_mov_b32 s7, 0
    s_mov_b32 s27, s99
    s_mov_b32 s26, s98
    s_waitcnt vmcnt(4)
    v_cmp_ne_u32 vcc, s24, v21
    s_cbranch_vccnz L_zr
L_zk:
    v_perm_b32 v64, v36, v32, s30
    v_perm_b32 v68, v36, v32, s31
    v_perm_b32 v72, v37, v33, s30
    v_perm_b32 v76, v37, v33, s31
    v_perm_b32 v80, v38, v34, s30
    v_perm_b32 v84, v38, v34, s31
    v_perm_b32 v88, v39, v35, s30
    v_perm_b32 v92, v39, v35, s31
    v_perm_b32 v65, v44, v40, s30
    v_perm_b32 v69, v44, v40, s31
    v_perm_b32 v73, v45, v41, s30
    v_perm_b32 v77, v45, v41, s31
    v_perm_b32 v81, v46, v42, s30
    v_perm_b32 v85, v46, v42, s31
    v_perm_b32 v89, v47, v43, s30
    v_perm_b32 v93, v47, v43, s31
    s_barrier
    buffer_load_dwordx4 v[12:15], v11, s[12:15], s98 offen sc1
    s_barrier
    buffer_load_dwordx4 v[96:99], v5, s[12:15], s27 offen sc1
    buffer_load_dwordx4 v[100:103], v5, s[12:15], s27 offen offset:1024 sc1
    s_waitcnt vmcnt(5)
    v_perm_b32 v66, v52, v48, s30
    v_perm_b32 v70, v52, v48, s31
    v_perm_b32 v74, v53, v49, s30
    v_perm_b32 v78, v53, v49, s31
    v_perm_b32 v82, v54, v50, s30
    v_perm_b32 v86, v54, v50, s31
    v_perm_b32 v90, v55, v51, s30
    v_perm_b32 v94, v55, v51, s31
    s_waitcnt vmcnt(3)
    v_perm_b32 v67, v60, v56, s30
    v_perm_b32 v71, v60, v56, s31
    v_perm_b32 v75, v61, v57, s30
    v_perm_b32 v79, v61, v57, s31
    v_perm_b32 v83, v62, v58, s30
    v_perm_b32 v87, v62, v58, s31
    v_perm_b32 v91, v63, v59, s30
    v_perm_b32 v95, v63, v59, s31
    s_waitcnt vmcnt(2)
L_Sc:
    v_xor_b32 v8, s24, v14
    v_bitop3_b32 v8, v15, s24, v8 bitop3:0xbe
    v_cmp_ne_u32 vcc, 0, v8
    v_mov_b32 v8, v12
    s_cbranch_vccnz L_Sp
L_Sd:
    v_mov_b32 v14, v8
    s_nop 1
    v_permlane32_swap_b32 v8, v14
    v_max_f32 v8, v8, v14
    v_mov_b32 v14, v8
    s_nop 1
    v_permlane16_swap_b32 v8, v14
    v_max_f32 v8, v8, v14
    v_sub_f32 v12, v12, v8
    v_exp_f32 v12, v12
    s_nop 0
    v_mul_f32 v8, v12, v13
    v_mov_b32 v14, v8
    s_nop 1
    v_permlane32_swap_b32 v8, v14
    v_add_f32 v8, v8, v14
    v_mov_b32 v14, v8
    s_nop 1
    v_permlane16_swap_b32 v8, v14
    v_add_f32 v8, v8, v14
    v_rcp_f32 v8, v8
    s_mov_b32 s7, 0
    v_mul_f32 v20, v12, v8
L_Ac:
    s_waitcnt vmcnt(1)
    v_xor_b32 v96, s8, v96
    v_xor_b32 v97, s9, v97
    v_xor_b32 v98, s10, v98
    v_xor_b32 v99, s11, v99
    v_or_b32 v8, v96, v97
    v_or3_b32 v8, v8, v98, v99
    v_pk_mul_f32 v[96:97], v[96:97], v[20:21] op_sel_hi:[1,0]
    v_pk_mul_f32 v[98:99], v[98:99], v[20:21] op_sel_hi:[1,0]
    s_waitcnt vmcnt(0)
    v_xor_b32 v100, s8, v100
    v_xor_b32 v101, s9, v101
    v_xor_b32 v102, s10, v102
    v_xor_b32 v103, s11, v103
    v_or3_b32 v8, v8, v100, v101
    v_or3_b32 v8, v8, v102, v103
    v_cmp_ne_u32_sdwa vcc, v8, 0 src0_sel:BYTE_0 src1_sel:DWORD
    v_pk_mul_f32 v[100:101], v[100:101], v[20:21] op_sel_hi:[1,0]
    v_pk_mul_f32 v[102:103], v[102:103], v[20:21] op_sel_hi:[1,0]
    s_mov_b64 exec, -1
    s_cbranch_vccnz L_Ap
L_Ad:
    v_permlane32_swap_b32 v96, v100
    v_permlane32_swap_b32 v97, v101
    v_permlane32_swap_b32 v98, v102
    v_permlane32_swap_b32 v99, v103
    v_pk_add_f32 v[96:97], v[96:97], v[100:101]
    v_pk_add_f32 v[98:99], v[98:99], v[102:103]
    s_nop 1
    v_permlane16_swap_b32 v96, v98
    v_permlane16_swap_b32 v97, v99
    v_pk_add_f32 v[96:97], v[96:97], v[98:99]
    v_cvt_pk_bf16_f32 v96, v96, v97
    s_nop 1
    v_mov_b32_dpp v24, v96 quad_perm:[0,0,0,0] row_mask:0xf bank_mask:0xf
    v_mov_b32_dpp v25, v96 quad_perm:[1,1,1,1] row_mask:0xf bank_mask:0xf
    v_mov_b32_dpp v26, v96 quad_perm:[2,2,2,2] row_mask:0xf bank_mask:0xf
    v_mov_b32_dpp v27, v96 quad_perm:[3,3,3,3] row_mask:0xf bank_mask:0xf
    s_nop 1
    v_mfma_f32_16x16x32_bf16 v[160:163], v[24:27], v[64:67], 0
    v_mfma_f32_16x16x32_bf16 v[164:167], v[24:27], v[68:71], 0
    v_mfma_f32_16x16x32_bf16 v[168:171], v[24:27], v[72:75], 0
    v_mfma_f32_16x16x32_bf16 v[172:175], v[24:27], v[76:79], 0
    v_mfma_f32_16x16x32_bf16 v[176:179], v[24:27], v[80:83], 0
    s_nop 3
    v_mov_b32 v96, v160
    v_mfma_f32_16x16x32_bf16 v[180:183], v[24:27], v[84:87], 0
    v_mov_b32 v97, v164
    v_mfma_f32_16x16x32_bf16 v[184:187], v[24:27], v[88:91], 0
    v_mov_b32 v98, v168
    v_mfma_f32_16x16x32_bf16 v[188:191], v[24:27], v[92:95], 0
    v_mov_b32 v99, v172
    ds_write_b128 v3, v[96:99]
    v_mov_b32 v100, v176
    s_nop 0
    v_mov_b32 v101, v180
    s_nop 0
    v_mov_b32 v102, v184
    s_nop 0
    v_mov_b32 v103, v188
    ds_write_b128 v3, v[100:103] offset:1024
    s_waitcnt lgkmcnt(0)
    s_barrier
    s_endpgm
L_Ap:
    s_add_u32 s7, s7, 1
    s_cmp_lt_u32 s7, 20000
    s_cbranch_scc0 L_Ad
    s_and_b32 s92, s7, 7
    s_cmp_eq_u32 s92, 7
    s_cselect_b32 s92, s95, 0
    s_add_u32 s27, s99, s92
    s_mov_b64 exec, vcc
    buffer_load_dwordx4 v[96:99], v5, s[12:15], s27 offen sc1
    buffer_load_dwordx4 v[100:103], v5, s[12:15], s27 offen offset:1024 sc1
    s_branch L_Ac
L_Sp:
    s_add_u32 s7, s7, 1
    s_cmp_lt_u32 s7, 20000
    s_cbranch_scc0 L_Sd
    s_and_b32 s92, s7, 7
    s_cmp_eq_u32 s92, 7
    s_cselect_b32 s92, s95, 0
    s_add_u32 s26, s98, s92
    buffer_load_dwordx4 v[12:15], v11, s[12:15], s26 offen sc1
    s_waitcnt vmcnt(0)
    s_branch L_Sc
L_PUB:

    s_barrier
    ds_read_b128 v[208:211], v3
    ds_read_b128 v[212:215], v3 offset:2048
    ds_read_b128 v[216:219], v3 offset:4096
    ds_read_b128 v[220:223], v3 offset:6144
    s_cmp_lt_u32 s28, 2
    s_waitcnt lgkmcnt(2)

    v_pk_add_f32 v[208:209], v[208:209], v[212:213]
    v_pk_add_f32 v[210:211], v[210:211], v[214:215]
    s_waitcnt lgkmcnt(0)
    v_pk_add_f32 v[216:217], v[216:217], v[220:221]
    v_pk_add_f32 v[218:219], v[218:219], v[222:223]
    v_pk_add_f32 v[208:209], v[208:209], v[216:217]
    v_pk_add_f32 v[210:211], v[210:211], v[218:219]
    v_and_or_b32 v224, v208, v9, s8
    v_and_or_b32 v225, v209, v9, s9
    v_and_or_b32 v226, v210, v9, s10
    v_and_or_b32 v227, v211, v9, s11

    s_cbranch_scc0 L_PUBg

    buffer_store_dwordx4 v[224:227], v7, s[12:15], s98 offen

    s_nop 0
    s_setpc_b64 s[90:91]
L_PUBg:
    s_cmp_eq_u32 s95, 0
    s_cbranch_scc1 L_PUBr
    buffer_store_dwordx4 v[224:227], v7, s[12:15], s98 offen sc1
    s_nop 0
L_PUBr:
    s_setpc_b64 s[90:91]

L_T4b:
    s_and_b32 s92, s4, 15
    s_lshl_b32 s92, s92, 2
    s_or_b32 s92, s92, s28
    s_cmp_eq_u32 s92, 3
    s_cbranch_scc0 L_T4c
    v_mov_b32 v20, 0
    v_mov_b32 v21, 0
    v_mov_b32 v22, 0
    v_mov_b32 v23, 0
    v_lshlrev_b32 v19, 4, v0
    s_lshl_b32 s92, s4, 3
    s_add_u32 s92, s92, 0x1000
    s_mov_b64 exec, 0xff
    buffer_store_dwordx4 v[20:23], v19, s[12:15], s92 offen sc1
    s_mov_b64 exec, -1
L_T4c:
    s_lshl_b32 s92, s6, 2
    s_or_b32 s92, s92, s28
    s_cmp_eq_u32 s92, 3
    s_cbranch_scc0 L_T4z
    v_mov_b64 v[20:21], 0
    v_mov_b64 v[22:23], 0
    v_lshlrev_b32 v19, 4, v0
    s_lshl_b32 s92, s5, 11
    s_add_u32 s92, s92, 0x140000
    buffer_store_dwordx4 v[20:23], v19, s[12:15], s92 offen offset:0 sc1
    buffer_store_dwordx4 v[20:23], v19, s[12:15], s92 offen offset:1024 sc1
L_T4z:

    s_and_b32 s101, s28, 1
    s_lshl_b32 s101, s101, 10
    s_add_u32 s92, s101, 0x1000
    v_lshl_add_u32 v3, v0, 4, s92
    s_lshr_b32 s92, s28, 1
    s_lshl_b32 s92, s92, 21
    s_add_u32 s101, s101, s92
    v_mov_b32 v9, 0xffffff00
    v_bfe_u32 v7, v0, 2, 2
    v_lshlrev_b32 v7, 11, v7
    v_lshrrev_b32 v8, 4, v0
    v_lshl_add_u32 v7, v8, 6, v7
    v_and_b32 v8, 3, v0
    v_lshl_add_u32 v7, v8, 4, v7

    s_getpc_b64 s[96:97]
Lpc_4:
    s_add_u32 s96, s96, L_PUB-Lpc_4
    s_addc_u32 s97, s97, -1
    s_lshl_b32 s98, s5, 13
    s_lshl_b32 s93, s6, 8
    s_add_u32 s98, s98, s93
    s_lshl_b32 s93, s101, 0
    s_add_u32 s98, s98, s93
    s_add_u32 s98, s98, 0x40000
    s_waitcnt lgkmcnt(0)
    s_add_u32 s24, s24, 0x01010101
    s_and_b32 s8, s24, 0xff
    s_bfe_u32 s9, s24, 0x80008
    s_bfe_u32 s10, s24, 0x80010
    s_lshr_b32 s11, s24, 24
    s_mov_b32 s95, 0
    s_swappc_b64 s[90:91], s[96:97]
    s_barrier
    s_and_b32 s92, s2, 7
    s_lshl_b32 s92, s92, 5

    v_and_b32 v16, 7, v0
    v_lshl_add_u32 v16, v16, 2, s92
    global_load_dword v16, v16, s[88:89] sc1

    v_mov_b32 v14, s24
    v_lshlrev_b32 v13, 12, v0
    v_lshlrev_b32 v2, 4, v0
    v_and_b32 v11, 15, v0
    v_lshlrev_b32 v11, 4, v11
    v_lshl_add_u32 v11, v4, 15, v11
    s_lshl_b32 s26, s28, 2
    s_or_b32 s26, s26, s6

    s_lshl_b32 s29, s5, 7
    s_add_u32 s29, s29, 0x2000
    s_lshl_b32 s27, s4, 8
    s_add_u32 s27, s27, 0x20000
    s_xor_b32 s29, s29, 0x100
    s_xor_b32 s27, s27, 0x800
    v_and_b32 v21, 3, v0
    v_lshlrev_b32 v21, 3, v21
    v_lshrrev_b32 v21, v21, s24
    v_lshlrev_b32 v22, 15, v21
    v_and_b32 v21, 0x55, v21
    v_and_b32 v22, 0x550000, v22
    v_or_b32 v21, v21, v22
    v_and_b32 v24, 0x10001, v21
    v_lshrrev_b32 v21, 2, v21
    v_and_b32 v25, 0x10001, v21
    v_lshrrev_b32 v21, 2, v21
    v_and_b32 v26, 0x10001, v21
    v_lshrrev_b32 v21, 2, v21
    v_and_b32 v27, 0x10001, v21
    s_waitcnt vmcnt(0)
    s_getreg_b32 s95, hwreg(HW_REG_XCC_ID, 0, 4)
    s_add_u32 s95, s95, 1
    s_mul_i32 s95, s95, 0x01010101
    v_cmp_ne_u32 vcc, s95, v16
    s_nop 1
    s_cmp_eq_u64 vcc, 0
    s_cselect_b32 s95, 0, 0x200000

    s_cmp_lg_u32 s95, 0
    s_cselect_b32 s92, s28, 0
    s_cmp_ge_u32 s92, 2
    s_cbranch_scc0 L_T4g
    buffer_store_dwordx4 v[224:227], v7, s[12:15], s98 offen sc1
L_T4g:

    s_barrier
    s_cmp_eq_u32 s26, 0
    s_cselect_b64 exec, 0xff, 0
    buffer_store_dword v14, v13, s[12:15], s29 offen sc1
    s_mov_b64 exec, -1

    s_mov_b32 s92, 0xfffefffe
    s_cmp_eq_u32 s28, 3
    s_barrier
    s_cbranch_scc0 L_T4q
    ds_read_b128 v[16:19], v2 offset:1024
    s_waitcnt lgkmcnt(0)
    v_and_or_b32 v16, v16, s92, v24
    v_and_or_b32 v17, v17, s92, v25
    v_and_or_b32 v18, v18, s92, v26
    v_and_or_b32 v19, v19, s92, v27
    buffer_store_dwordx4 v[16:19], v11, s[12:15], s27 offen sc1
L_T4q:

    s_barrier
    v_bfe_u32 v6, v0, 2, 2
    v_lshlrev_b32 v5, 4, v8
    v_lshl_add_u32 v1, v4, 6, v5
    v_lshl_add_u32 v1, v6, 8, v1
    s_lshr_b32 s26, s4, 4
    s_bfe_u32 s27, s4, 0x20002
    v_lshlrev_b32 v21, 3, v6
    v_add_u32 v21, 0x800, v21
    s_lshl_b32 s92, s28, 5
    v_add_u32 v20, s92, v21
    v_mov_b32 v23, 0

    s_and_b32 s92, s6, 1
    s_lshr_b32 s29, s6, 1
    s_lshl_b32 s25, s27, 23
    s_lshl_b32 s93, s26, 20
    s_add_u32 s25, s25, s93
    s_lshl_b32 s93, s92, 14
    s_add_u32 s25, s25, s93
    s_lshl_b32 s93, s29, 17
    s_add_u32 s25, s25, s93
    s_lshl_b32 s93, s28, 15
    s_add_u32 s25, s25, s93
    s_add_u32 s25, s25, 0xc0000
    s_bfe_u32 s92, s25, 0x10011
    s_lshl_b32 s92, s92, 13
    s_xor_b32 s25, s25, s92
    s_mov_b32 s16, s66
    s_mov_b32 s17, s67
    s_mov_b32 s18, 0x2000000
    s_mov_b32 s19, 0x20000
    s_mov_b32 s20, s68
    s_mov_b32 s21, s69
    s_mov_b32 s22, 0x2000000
    s_mov_b32 s23, 0x20000
    s_mov_b32 s30, 0x05040100
    s_mov_b32 s31, 0x07060302

    s_cmp_eq_u32 s28, 1
    s_cbranch_scc0 L_T4t
    s_mov_b32 exec_lo, 0
    buffer_load_dword v12, v10, s[12:15], s99 offen sc1
    s_lshl_b32 s92, s5, 8
    s_add_u32 s92, s92, 0xc000
    s_mov_b64 exec, 3
    buffer_load_dword v12, v10, s[12:15], s92 offen sc1
    s_mov_b64 exec, -1
L_T4t:

    s_lshr_b32 s92, s4, 5
    s_lshl_b32 s92, s92, 11
    s_add_u32 s92, s92, 0
    s_bfe_u32 s93, s4, 0x20003
    s_lshl_b32 s93, s93, 8
    s_add_u32 s92, s92, s93
    s_and_b32 s93, s4, 2
    s_lshl_b32 s93, s93, 6
    s_add_u32 s92, s92, s93
    v_mov_b32 v240, s92
    s_cmp_eq_u32 s28, 1
    s_cselect_b64 exec, 1, 0
    global_load_dword v241, v240, s[86:87] sc1
    s_mov_b64 exec, -1
    buffer_load_dwordx4 v[32:35], v1, s[16:19], s25 offen offset:0 nt
    buffer_load_dwordx4 v[36:39], v1, s[16:19], s25 offen offset:1024 nt
    buffer_load_dwordx4 v[40:43], v1, s[16:19], s25 offen offset:2048 nt
    s_waitcnt vmcnt(7)
    buffer_load_dwordx4 v[44:47], v1, s[16:19], s25 offen offset:3072 nt
    s_xor_b32 s25, s25, 0x1000
    s_waitcnt vmcnt(7)
    buffer_load_dwordx4 v[48:51], v1, s[16:19], s25 offen offset:0 nt
    s_waitcnt vmcnt(7)
    buffer_load_dwordx4 v[52:55], v1, s[16:19], s25 offen offset:1024 nt
    s_waitcnt vmcnt(7)
    buffer_load_dwordx4 v[56:59], v1, s[16:19], s25 offen offset:2048 nt
    s_waitcnt vmcnt(7)
    buffer_load_dwordx4 v[60:63], v1, s[16:19], s25 offen offset:3072 nt
    s_xor_b32 s25, s25, 0x3000
    v_add_u32 v3, 0x2000, v3
    s_add_u32 s98, s98, 0x40000
    s_xor_b32 s98, s98, 0x2000
    s_swappc_b64 s[90:91], s[96:97]
    s_barrier
    v_add_u32 v3, 0xffffe000, v3
    s_waitcnt vmcnt(7)
    buffer_load_dwordx4 v[64:67], v1, s[16:19], s25 offen offset:0 nt
    s_waitcnt vmcnt(7)
    buffer_load_dwordx4 v[68:71], v1, s[16:19], s25 offen offset:1024 nt
    s_waitcnt vmcnt(7)
    buffer_load_dwordx4 v[72:75], v1, s[16:19], s25 offen offset:2048 nt
    s_waitcnt vmcnt(7)
    buffer_load_dwordx4 v[76:79], v1, s[16:19], s25 offen offset:3072 nt
    s_xor_b32 s25, s25, 0x1000
    s_waitcnt vmcnt(7)
    buffer_load_dwordx4 v[80:83], v1, s[16:19], s25 offen offset:0 nt
    s_waitcnt vmcnt(7)
    buffer_load_dwordx4 v[84:87], v1, s[16:19], s25 offen offset:1024 nt
    s_waitcnt vmcnt(7)
    buffer_load_dwordx4 v[88:91], v1, s[16:19], s25 offen offset:2048 nt
    s_waitcnt vmcnt(7)
    buffer_load_dwordx4 v[92:95], v1, s[16:19], s25 offen offset:3072 nt
    s_xor_b32 s25, s25, 0x3000
    s_waitcnt vmcnt(7)
    buffer_load_dwordx4 v[96:99], v2, s[20:23], s25 offen offset:0 nt
    s_waitcnt vmcnt(7)
    buffer_load_dwordx4 v[100:103], v2, s[20:23], s25 offen offset:1024 nt
    s_waitcnt vmcnt(7)
    buffer_load_dwordx4 v[104:107], v2, s[20:23], s25 offen offset:2048 nt
    s_waitcnt vmcnt(7)
    buffer_load_dwordx4 v[108:111], v2, s[20:23], s25 offen offset:3072 nt
    s_xor_b32 s25, s25, 0x1000
    s_waitcnt vmcnt(7)
    buffer_load_dwordx4 v[112:115], v2, s[20:23], s25 offen offset:0 nt
    s_waitcnt vmcnt(7)
    buffer_load_dwordx4 v[116:119], v2, s[20:23], s25 offen offset:1024 nt
    s_waitcnt vmcnt(7)
    buffer_load_dwordx4 v[120:123], v2, s[20:23], s25 offen offset:2048 nt
    s_waitcnt vmcnt(7)
    buffer_load_dwordx4 v[124:127], v2, s[20:23], s25 offen offset:3072 nt
    s_xor_b32 s25, s25, 0x3000
    s_lshl_b32 s100, s26, 10
    s_lshl_b32 s93, s28, 8
    s_add_u32 s100, s100, s93
    s_lshl_b32 s93, s6, 6
    s_add_u32 s100, s100, s93
    s_lshl_b32 s93, s27, 4
    s_add_u32 s100, s100, s93
    s_add_u32 s100, s100, 0xc000
    s_lshl_b32 s98, s26, 15
    s_lshl_b32 s93, s6, 8
    s_add_u32 s98, s98, s93
    s_lshl_b32 s93, s27, 6
    s_add_u32 s98, s98, s93
    s_lshl_b32 s93, s101, 0
    s_add_u32 s98, s98, s93
    s_add_u32 s98, s98, 0xc0000
    s_and_b32 s92, s5, 3
    s_andn2_b32 s5, s5, 3
    s_or_b32 s5, s5, s6
    s_xor_b32 s6, s92, 0

    v_lshrrev_b32 v7, 2, v0
    v_lshl_add_u32 v7, v7, 11, v5
    s_lshl_b32 s92, s28, 11
    s_add_u32 s92, s92, 0x1000
    v_add_u32 v22, s92, v2
    s_mov_b32 s29, 0x3e0293ee
    s_barrier
    ds_read_b128 v[28:31], v1

    s_waitcnt lgkmcnt(0)
    v_mfma_f32_16x16x32_bf16 v[160:163], v[32:35], v[28:31], 0
    v_mfma_f32_16x16x32_bf16 v[164:167], v[36:39], v[28:31], 0
    v_mfma_f32_16x16x32_bf16 v[168:171], v[40:43], v[28:31], 0
    v_mfma_f32_16x16x32_bf16 v[172:175], v[44:47], v[28:31], 0
    v_mfma_f32_16x16x32_bf16 v[176:179], v[48:51], v[28:31], 0
    v_mfma_f32_16x16x32_bf16 v[180:183], v[52:55], v[28:31], 0
    v_mfma_f32_16x16x32_bf16 v[184:187], v[56:59], v[28:31], 0
    v_mfma_f32_16x16x32_bf16 v[188:191], v[60:63], v[28:31], 0
    s_nop 0
    v_add_f32_dpp v192, v161, v160 quad_perm:[1,1,1,1] row_mask:0xf bank_mask:0xf
    v_add_f32_dpp v193, v165, v164 quad_perm:[1,1,1,1] row_mask:0xf bank_mask:0xf
    v_add_f32_dpp v194, v169, v168 quad_perm:[1,1,1,1] row_mask:0xf bank_mask:0xf
    v_add_f32_dpp v195, v173, v172 quad_perm:[1,1,1,1] row_mask:0xf bank_mask:0xf
    v_add_f32_dpp v196, v177, v176 quad_perm:[1,1,1,1] row_mask:0xf bank_mask:0xf
    v_add_f32_dpp v197, v181, v180 quad_perm:[1,1,1,1] row_mask:0xf bank_mask:0xf
    v_add_f32_dpp v198, v185, v184 quad_perm:[1,1,1,1] row_mask:0xf bank_mask:0xf
    v_add_f32_dpp v199, v189, v188 quad_perm:[1,1,1,1] row_mask:0xf bank_mask:0xf
    v_add_f32_dpp v192, v162, v192 quad_perm:[2,2,2,2] row_mask:0xf bank_mask:0xf
    v_add_f32_dpp v193, v166, v193 quad_perm:[2,2,2,2] row_mask:0xf bank_mask:0xf
    v_add_f32_dpp v194, v170, v194 quad_perm:[2,2,2,2] row_mask:0xf bank_mask:0xf
    v_add_f32_dpp v195, v174, v195 quad_perm:[2,2,2,2] row_mask:0xf bank_mask:0xf
    v_add_f32_dpp v196, v178, v196 quad_perm:[2,2,2,2] row_mask:0xf bank_mask:0xf
    v_add_f32_dpp v197, v182, v197 quad_perm:[2,2,2,2] row_mask:0xf bank_mask:0xf
    v_add_f32_dpp v198, v186, v198 quad_perm:[2,2,2,2] row_mask:0xf bank_mask:0xf
    v_add_f32_dpp v199, v190, v199 quad_perm:[2,2,2,2] row_mask:0xf bank_mask:0xf
    v_add_f32_dpp v192, v163, v192 quad_perm:[3,3,3,3] row_mask:0xf bank_mask:0xf
    v_add_f32_dpp v193, v167, v193 quad_perm:[3,3,3,3] row_mask:0xf bank_mask:0xf
    v_add_f32_dpp v194, v171, v194 quad_perm:[3,3,3,3] row_mask:0xf bank_mask:0xf
    v_add_f32_dpp v195, v175, v195 quad_perm:[3,3,3,3] row_mask:0xf bank_mask:0xf
    v_add_f32_dpp v196, v179, v196 quad_perm:[3,3,3,3] row_mask:0xf bank_mask:0xf
    v_add_f32_dpp v197, v183, v197 quad_perm:[3,3,3,3] row_mask:0xf bank_mask:0xf
    v_add_f32_dpp v198, v187, v198 quad_perm:[3,3,3,3] row_mask:0xf bank_mask:0xf
    v_add_f32_dpp v199, v191, v199 quad_perm:[3,3,3,3] row_mask:0xf bank_mask:0xf
    v_mfma_f32_16x16x32_bf16 v[160:163], v[64:67], v[28:31], 0
    v_mfma_f32_16x16x32_bf16 v[164:167], v[68:71], v[28:31], 0
    v_mfma_f32_16x16x32_bf16 v[168:171], v[72:75], v[28:31], 0
    v_mfma_f32_16x16x32_bf16 v[172:175], v[76:79], v[28:31], 0
    v_mfma_f32_16x16x32_bf16 v[176:179], v[80:83], v[28:31], 0
    v_mfma_f32_16x16x32_bf16 v[180:183], v[84:87], v[28:31], 0
    v_mfma_f32_16x16x32_bf16 v[184:187], v[88:91], v[28:31], 0
    v_mfma_f32_16x16x32_bf16 v[188:191], v[92:95], v[28:31], 0
    s_nop 0
    v_add_f32_dpp v200, v161, v160 quad_perm:[1,1,1,1] row_mask:0xf bank_mask:0xf
    v_add_f32_dpp v201, v165, v164 quad_perm:[1,1,1,1] row_mask:0xf bank_mask:0xf
    v_add_f32_dpp v202, v169, v168 quad_perm:[1,1,1,1] row_mask:0xf bank_mask:0xf
    v_add_f32_dpp v203, v173, v172 quad_perm:[1,1,1,1] row_mask:0xf bank_mask:0xf
    v_add_f32_dpp v204, v177, v176 quad_perm:[1,1,1,1] row_mask:0xf bank_mask:0xf
    v_add_f32_dpp v205, v181, v180 quad_perm:[1,1,1,1] row_mask:0xf bank_mask:0xf
    v_add_f32_dpp v206, v185, v184 quad_perm:[1,1,1,1] row_mask:0xf bank_mask:0xf
    v_add_f32_dpp v207, v189, v188 quad_perm:[1,1,1,1] row_mask:0xf bank_mask:0xf
    v_add_f32_dpp v200, v162, v200 quad_perm:[2,2,2,2] row_mask:0xf bank_mask:0xf
    v_add_f32_dpp v201, v166, v201 quad_perm:[2,2,2,2] row_mask:0xf bank_mask:0xf
    v_add_f32_dpp v202, v170, v202 quad_perm:[2,2,2,2] row_mask:0xf bank_mask:0xf
    v_add_f32_dpp v203, v174, v203 quad_perm:[2,2,2,2] row_mask:0xf bank_mask:0xf
    v_add_f32_dpp v204, v178, v204 quad_perm:[2,2,2,2] row_mask:0xf bank_mask:0xf
    v_add_f32_dpp v205, v182, v205 quad_perm:[2,2,2,2] row_mask:0xf bank_mask:0xf
    v_add_f32_dpp v206, v186, v206 quad_perm:[2,2,2,2] row_mask:0xf bank_mask:0xf
    v_add_f32_dpp v207, v190, v207 quad_perm:[2,2,2,2] row_mask:0xf bank_mask:0xf
    v_add_f32_dpp v200, v163, v200 quad_perm:[3,3,3,3] row_mask:0xf bank_mask:0xf
    v_add_f32_dpp v201, v167, v201 quad_perm:[3,3,3,3] row_mask:0xf bank_mask:0xf
    v_add_f32_dpp v202, v171, v202 quad_perm:[3,3,3,3] row_mask:0xf bank_mask:0xf
    v_add_f32_dpp v203, v175, v203 quad_perm:[3,3,3,3] row_mask:0xf bank_mask:0xf
    v_add_f32_dpp v204, v179, v204 quad_perm:[3,3,3,3] row_mask:0xf bank_mask:0xf
    v_add_f32_dpp v205, v183, v205 quad_perm:[3,3,3,3] row_mask:0xf bank_mask:0xf
    v_add_f32_dpp v206, v187, v206 quad_perm:[3,3,3,3] row_mask:0xf bank_mask:0xf
    v_add_f32_dpp v207, v191, v207 quad_perm:[3,3,3,3] row_mask:0xf bank_mask:0xf
    v_max3_f32 v12, v192, v193, v194
    v_max3_f32 v12, v12, v195, v196
    v_max3_f32 v12, v12, v197, v198
    v_max3_f32 v12, v12, v199, v200
    v_max3_f32 v12, v12, v201, v202
    v_max3_f32 v12, v12, v203, v204
    v_max3_f32 v12, v12, v205, v206
    v_max_f32 v12, v12, v207
    v_mov_b32 v16, v12
    s_nop 1
    v_permlane32_swap_b32 v12, v16
    v_max_f32 v12, v12, v16
    v_mov_b32 v16, v12
    s_nop 1
    v_permlane16_swap_b32 v12, v16
    v_max_f32 v12, v12, v16
    v_mul_f32 v12, s29, v12
    v_fma_f32 v192, v192, s29, -v12
    v_fma_f32 v193, v193, s29, -v12
    v_fma_f32 v194, v194, s29, -v12
    v_fma_f32 v195, v195, s29, -v12
    v_fma_f32 v196, v196, s29, -v12
    v_fma_f32 v197, v197, s29, -v12
    v_fma_f32 v198, v198, s29, -v12
    v_fma_f32 v199, v199, s29, -v12
    v_fma_f32 v200, v200, s29, -v12
    v_fma_f32 v201, v201, s29, -v12
    v_fma_f32 v202, v202, s29, -v12
    v_fma_f32 v203, v203, s29, -v12
    v_fma_f32 v204, v204, s29, -v12
    v_fma_f32 v205, v205, s29, -v12
    v_fma_f32 v206, v206, s29, -v12
    v_fma_f32 v207, v207, s29, -v12
    v_exp_f32 v192, v192
    v_exp_f32 v193, v193
    v_exp_f32 v194, v194
    v_exp_f32 v195, v195
    v_exp_f32 v196, v196
    v_exp_f32 v197, v197
    v_exp_f32 v198, v198
    v_exp_f32 v199, v199
    v_exp_f32 v200, v200
    v_exp_f32 v201, v201
    v_exp_f32 v202, v202
    v_exp_f32 v203, v203
    v_exp_f32 v204, v204
    v_exp_f32 v205, v205
    v_exp_f32 v206, v206
    v_exp_f32 v207, v207
    v_add_f32 v208, v192, v200
    v_add_f32 v209, v193, v201
    v_add_f32 v210, v194, v202
    v_add_f32 v211, v195, v203
    v_add_f32 v212, v196, v204
    v_add_f32 v213, v197, v205
    v_add_f32 v214, v198, v206
    v_add_f32 v215, v199, v207
    v_add_f32 v208, v208, v212
    v_add_f32 v209, v209, v213
    v_add_f32 v210, v210, v214
    v_add_f32 v211, v211, v215
    v_add_f32 v208, v208, v210
    v_add_f32 v209, v209, v211
    v_add_f32 v13, v208, v209
    v_mov_b32 v16, v13
    s_nop 1
    v_permlane32_swap_b32 v13, v16
    v_add_f32 v13, v13, v16
    v_mov_b32 v16, v13
    s_nop 1
    v_permlane16_swap_b32 v13, v16
    v_add_f32 v13, v13, v16

    s_mov_b64 exec, 0x1111
    ds_write_b64 v20, v[12:13]
    s_mov_b64 exec, -1

    buffer_load_dwordx4 v[128:131], v2, s[20:23], s25 offen offset:0 nt
    buffer_load_dwordx4 v[132:135], v2, s[20:23], s25 offen offset:1024 nt
    buffer_load_dwordx4 v[136:139], v2, s[20:23], s25 offen offset:2048 nt
    buffer_load_dwordx4 v[140:143], v2, s[20:23], s25 offen offset:3072 nt
    s_xor_b32 s25, s25, 0x1000
    buffer_load_dwordx4 v[144:147], v2, s[20:23], s25 offen offset:0 nt
    buffer_load_dwordx4 v[148:151], v2, s[20:23], s25 offen offset:1024 nt
    buffer_load_dwordx4 v[152:155], v2, s[20:23], s25 offen offset:2048 nt
    buffer_load_dwordx4 v[156:159], v2, s[20:23], s25 offen offset:3072 nt

    s_waitcnt lgkmcnt(0)
    s_barrier
    ds_read_b64 v[208:209], v21
    ds_read_b64 v[210:211], v21 offset:32
    ds_read_b64 v[212:213], v21 offset:64
    ds_read_b64 v[214:215], v21 offset:96
    s_lshl_b32 s92, s28, 2
    s_lshl_b64 s[92:93], 1, s92
    s_add_u32 s29, s100, 0x200000
    s_waitcnt lgkmcnt(0)
    v_max3_f32 v16, v208, v210, v212
    v_max_f32 v16, v16, v214
    v_sub_f32 v12, v12, v16
    v_sub_f32 v208, v208, v16
    v_sub_f32 v210, v210, v16
    v_sub_f32 v212, v212, v16
    v_sub_f32 v214, v214, v16
    v_exp_f32 v12, v12
    v_exp_f32 v208, v208
    v_exp_f32 v210, v210
    v_exp_f32 v212, v212
    v_exp_f32 v214, v214
    v_mul_f32 v17, v208, v209
    v_fmac_f32 v17, v210, v211
    v_fmac_f32 v17, v212, v213
    v_fmac_f32 v17, v214, v215
    v_mov_b32 v18, s24
    v_mov_b32 v19, s24
    s_mov_b64 exec, s[92:93]

    buffer_store_dwordx4 v[16:19], v23, s[12:15], s100 offen
    s_cmp_eq_u32 s95, 0
    s_cbranch_scc1 L_T4s
    buffer_store_dwordx4 v[16:19], v23, s[12:15], s29 offen sc1
L_T4s:
    s_mov_b64 exec, -1
    v_mul_f32 v192, v192, v12
    v_mul_f32 v193, v193, v12
    v_mul_f32 v194, v194, v12
    v_mul_f32 v195, v195, v12
    v_mul_f32 v196, v196, v12
    v_mul_f32 v197, v197, v12
    v_mul_f32 v198, v198, v12
    v_mul_f32 v199, v199, v12
    v_mul_f32 v200, v200, v12
    v_mul_f32 v201, v201, v12
    v_mul_f32 v202, v202, v12
    v_mul_f32 v203, v203, v12
    v_mul_f32 v204, v204, v12
    v_mul_f32 v205, v205, v12
    v_mul_f32 v206, v206, v12
    v_mul_f32 v207, v207, v12
    v_cvt_pk_bf16_f32 v240, v192, v193
    v_cvt_pk_bf16_f32 v241, v194, v195
    v_cvt_pk_bf16_f32 v242, v196, v197
    v_cvt_pk_bf16_f32 v243, v198, v199
    v_cvt_pk_bf16_f32 v244, v200, v201
    v_cvt_pk_bf16_f32 v245, v202, v203
    v_cvt_pk_bf16_f32 v246, v204, v205
    v_cvt_pk_bf16_f32 v247, v206, v207
    s_waitcnt vmcnt(9)
    v_perm_b32 v208, v100, v96, s30
    v_perm_b32 v209, v108, v104, s30
    v_perm_b32 v210, v116, v112, s30
    v_perm_b32 v211, v124, v120, s30
    v_perm_b32 v212, v100, v96, s31
    v_perm_b32 v213, v108, v104, s31
    v_perm_b32 v214, v116, v112, s31
    v_perm_b32 v215, v124, v120, s31
    v_mfma_f32_16x16x32_bf16 v[160:163], v[240:243], v[208:211], 0
    v_perm_b32 v216, v101, v97, s30
    v_perm_b32 v217, v109, v105, s30
    v_perm_b32 v218, v117, v113, s30
    v_perm_b32 v219, v125, v121, s30
    v_mfma_f32_16x16x32_bf16 v[164:167], v[240:243], v[212:215], 0
    v_perm_b32 v220, v101, v97, s31
    v_perm_b32 v221, v109, v105, s31
    v_perm_b32 v222, v117, v113, s31
    v_perm_b32 v223, v125, v121, s31
    v_mfma_f32_16x16x32_bf16 v[168:171], v[240:243], v[216:219], 0
    v_perm_b32 v224, v102, v98, s30
    v_perm_b32 v225, v110, v106, s30
    v_perm_b32 v226, v118, v114, s30
    v_perm_b32 v227, v126, v122, s30
    v_mfma_f32_16x16x32_bf16 v[172:175], v[240:243], v[220:223], 0
    v_perm_b32 v228, v102, v98, s31
    v_perm_b32 v229, v110, v106, s31
    v_perm_b32 v230, v118, v114, s31
    v_perm_b32 v231, v126, v122, s31
    v_mfma_f32_16x16x32_bf16 v[176:179], v[240:243], v[224:227], 0
    v_perm_b32 v232, v103, v99, s30
    v_perm_b32 v233, v111, v107, s30
    v_perm_b32 v234, v119, v115, s30
    v_perm_b32 v235, v127, v123, s30
    v_mfma_f32_16x16x32_bf16 v[180:183], v[240:243], v[228:231], 0
    v_perm_b32 v236, v103, v99, s31
    v_perm_b32 v237, v111, v107, s31
    v_perm_b32 v238, v119, v115, s31
    v_perm_b32 v239, v127, v123, s31
    v_mfma_f32_16x16x32_bf16 v[184:187], v[240:243], v[232:235], 0
    s_nop 0
    v_mfma_f32_16x16x32_bf16 v[188:191], v[240:243], v[236:239], 0
    s_waitcnt vmcnt(7)
    v_perm_b32 v208, v132, v128, s30
    v_perm_b32 v212, v132, v128, s31
    v_perm_b32 v216, v133, v129, s30
    v_perm_b32 v220, v133, v129, s31
    v_perm_b32 v224, v134, v130, s30
    v_perm_b32 v228, v134, v130, s31
    v_perm_b32 v232, v135, v131, s30
    v_perm_b32 v236, v135, v131, s31
    s_waitcnt vmcnt(5)
    v_perm_b32 v209, v140, v136, s30
    v_perm_b32 v213, v140, v136, s31
    v_perm_b32 v217, v141, v137, s30
    v_perm_b32 v221, v141, v137, s31
    v_perm_b32 v225, v142, v138, s30
    v_perm_b32 v229, v142, v138, s31
    v_perm_b32 v233, v143, v139, s30
    v_perm_b32 v237, v143, v139, s31
    s_waitcnt vmcnt(3)
    v_perm_b32 v210, v148, v144, s30
    v_perm_b32 v214, v148, v144, s31
    v_perm_b32 v218, v149, v145, s30
    v_perm_b32 v222, v149, v145, s31
    v_perm_b32 v226, v150, v146, s30
    v_perm_b32 v230, v150, v146, s31
    v_perm_b32 v234, v151, v147, s30
    v_perm_b32 v238, v151, v147, s31
    s_waitcnt vmcnt(1)
    v_perm_b32 v211, v156, v152, s30
    v_perm_b32 v215, v156, v152, s31
    v_perm_b32 v219, v157, v153, s30
    v_mfma_f32_16x16x32_bf16 v[160:163], v[244:247], v[208:211], v[160:163]
    v_perm_b32 v223, v157, v153, s31
    v_mfma_f32_16x16x32_bf16 v[164:167], v[244:247], v[212:215], v[164:167]
    v_perm_b32 v227, v158, v154, s30
    v_mfma_f32_16x16x32_bf16 v[168:171], v[244:247], v[216:219], v[168:171]
    v_perm_b32 v231, v158, v154, s31
    v_mfma_f32_16x16x32_bf16 v[172:175], v[244:247], v[220:223], v[172:175]
    s_nop 1
    v_mov_b32 v192, v160
    v_perm_b32 v235, v159, v155, s30
    v_mfma_f32_16x16x32_bf16 v[176:179], v[244:247], v[224:227], v[176:179]
    v_mov_b32 v193, v164
    v_perm_b32 v239, v159, v155, s31
    v_mfma_f32_16x16x32_bf16 v[180:183], v[244:247], v[228:231], v[180:183]
    v_mov_b32 v194, v168
    v_mfma_f32_16x16x32_bf16 v[184:187], v[244:247], v[232:235], v[184:187]
    v_mov_b32 v195, v172
    ds_write_b128 v22, v[192:195]
    v_mfma_f32_16x16x32_bf16 v[188:191], v[244:247], v[236:239], v[188:191]
    v_mov_b32 v196, v176
    s_nop 1
    v_mov_b32 v197, v180
    s_nop 0
    v_mov_b32 v198, v184
    s_nop 1
    v_mov_b32 v199, v188
    ds_write_b128 v22, v[196:199] offset:1024
    s_mov_b32 s100, 0
    s_waitcnt lgkmcnt(0)
L_TAIL:
    s_swappc_b64 s[90:91], s[96:97]
    s_barrier
L_TAILb:
    s_mov_b32 s20, s86
    s_mov_b32 s21, s87
    s_mov_b32 s22, 0x2000
    s_mov_b32 s23, 0x20000
    s_lshl_b32 s92, s2, 2
    s_or_b32 s92, s92, s28
    v_mov_b32 v6, s24
    v_mov_b32 v2, 0
    s_cmp_eq_u32 s92, 513
    s_cselect_b64 exec, 1, 0
    buffer_store_dword v6, v2, s[12:15], 0 offen sc1
    s_mov_b64 exec, -1
    s_mul_i32 s26, s28, 144
    v_lshrrev_b32 v4, 2, v0
    v_and_b32 v5, 3, v0
    v_cmp_eq_u32 s[74:75], 3, v5
    v_mad_u32_u24 v4, v4, 3, s26
    v_add_u32 v5, v4, v5
    s_movk_i32 s92, 0x3000
    s_cmp_eq_u32 s100, 0
    s_cselect_b32 s92, s92, 0x26000
    v_lshl_add_u32 v3, v5, 2, s92
    s_add_u32 s92, s92, 2044
    v_add_u32 v14, 192, v3
    v_add_u32 v15, 384, v3
    v_min_u32 v14, s92, v14
    v_min_u32 v15, s92, v15
    v_cndmask_b32 v4, v5, v4, s[74:75]
    s_movk_i32 s92, 512
    v_cmp_gt_u32 s[64:65], s92, v4
    v_bfe_u32 v8, v5, 6, 2
    v_lshlrev_b32 v10, 11, v8
    v_bfe_u32 v8, v5, 2, 4
    v_lshl_add_u32 v10, v8, 4, v10
    v_lshrrev_b32 v8, 8, v5
    v_lshl_add_u32 v10, v8, 3, v10
    v_and_b32 v8, 3, v5
    v_lshl_add_u32 v10, v8, 1, v10
    v_add_u32 v4, 48, v4
    v_add_u32 v5, 48, v5
    v_cmp_gt_u32 s[66:67], s92, v4
    v_bfe_u32 v8, v5, 6, 2
    v_lshlrev_b32 v11, 11, v8
    v_bfe_u32 v8, v5, 2, 4
    v_lshl_add_u32 v11, v8, 4, v11
    v_lshrrev_b32 v8, 8, v5
    v_lshl_add_u32 v11, v8, 3, v11
    v_and_b32 v8, 3, v5
    v_lshl_add_u32 v11, v8, 1, v11
    v_add_u32 v4, 48, v4
    v_add_u32 v5, 48, v5
    v_cmp_gt_u32 s[68:69], s92, v4
    v_bfe_u32 v8, v5, 6, 2
    v_lshlrev_b32 v12, 11, v8
    v_bfe_u32 v8, v5, 2, 4
    v_lshl_add_u32 v12, v8, 4, v12
    v_lshrrev_b32 v8, 8, v5
    v_lshl_add_u32 v12, v8, 3, v12
    v_and_b32 v8, 3, v5
    v_lshl_add_u32 v12, v8, 1, v12
    v_add_u32 v4, 48, v4
    v_add_u32 v5, 48, v5
    v_lshrrev_b32 v2, 4, v0
    v_lshlrev_b32 v2, 7, v2
    v_and_b32 v8, 15, v0
    v_lshl_add_u32 v2, v8, 2, v2
    s_mul_i32 s26, s28, 1536
    s_mov_b32 s29, 0x41f80000
    s_lshl_b32 s25, s100, 15
    s_lshl_b32 s93, s6, 13
    s_add_u32 s25, s25, s93
    s_lshl_b32 s93, s26, 0
    s_add_u32 s25, s25, s93
    s_add_u32 s25, s25, 0x140000
    s_lshl_b32 s27, s100, 10
    s_lshl_b32 s93, s6, 8
    s_add_u32 s27, s27, s93
    s_barrier
    ds_read2st64_b32 v[32:33], v3 offset1:8
    ds_read2st64_b32 v[34:35], v3 offset0:16 offset1:24
    ds_read2st64_b32 v[36:37], v14 offset1:8
    ds_read2st64_b32 v[38:39], v14 offset0:16 offset1:24
    ds_read2st64_b32 v[40:41], v15 offset1:8
    ds_read2st64_b32 v[42:43], v15 offset0:16 offset1:24
    s_waitcnt lgkmcnt(4)
    v_pk_add_f32 v[32:33], v[32:33], v[34:35]
    v_add_f32 v33, v32, v33
    v_cndmask_b32 v32, v33, 1.0, s[74:75]
    s_mov_b64 exec, s[64:65]
    buffer_atomic_add_f32 v32, v2, s[12:15], s25 offen offset:0 sc0 sc1
    s_mov_b64 exec, -1
    s_waitcnt lgkmcnt(2)
    v_pk_add_f32 v[36:37], v[36:37], v[38:39]
    v_add_f32 v37, v36, v37
    v_cndmask_b32 v36, v37, 1.0, s[74:75]
    s_mov_b64 exec, s[66:67]
    buffer_atomic_add_f32 v36, v2, s[12:15], s25 offen offset:512 sc0 sc1
    s_mov_b64 exec, -1
    s_waitcnt lgkmcnt(0)
    v_pk_add_f32 v[40:41], v[40:41], v[42:43]
    v_add_f32 v41, v40, v41
    v_cndmask_b32 v40, v41, 1.0, s[74:75]
    s_mov_b64 exec, s[68:69]
    buffer_atomic_add_f32 v40, v2, s[12:15], s25 offen offset:1024 sc0 sc1
    s_mov_b64 exec, -1
    s_andn2_b64 s[64:65], s[64:65], s[74:75]
    s_andn2_b64 s[66:67], s[66:67], s[74:75]
    s_andn2_b64 s[68:69], s[68:69], s[74:75]
    s_waitcnt vmcnt(2)
    v_mov_b32_dpp v34, v32 quad_perm:[3,3,3,3] row_mask:0xf bank_mask:0xf
    v_add_f32 v32, v32, v33
    v_cmp_eq_f32 vcc, s29, v34
    v_cvt_pk_bf16_f32 v32, v32, v32
    s_nop 0
    s_and_b64 s[64:65], s[64:65], vcc
    s_waitcnt vmcnt(1)
    v_mov_b32_dpp v38, v36 quad_perm:[3,3,3,3] row_mask:0xf bank_mask:0xf
    v_add_f32 v36, v36, v37
    v_cmp_eq_f32 vcc, s29, v38
    v_cvt_pk_bf16_f32 v36, v36, v36
    s_nop 0
    s_and_b64 s[66:67], s[66:67], vcc
    s_waitcnt vmcnt(0)
    v_mov_b32_dpp v42, v40 quad_perm:[3,3,3,3] row_mask:0xf bank_mask:0xf
    v_add_f32 v40, v40, v41
    v_cmp_eq_f32 vcc, s29, v42
    v_cvt_pk_bf16_f32 v40, v40, v40
    s_nop 0
    s_and_b64 s[68:69], s[68:69], vcc
    s_mov_b64 exec, s[64:65]
    buffer_store_short v32, v10, s[20:23], s27 offen
    s_mov_b64 exec, s[66:67]
    buffer_store_short v36, v11, s[20:23], s27 offen
    s_mov_b64 exec, s[68:69]
    buffer_store_short v40, v12, s[20:23], s27 offen
    s_endpgm
L_B:
    s_lshr_b32 s5, s4, 2
    s_and_b32 s6, s4, 3
    s_mov_b32 s14, 0x10000000
    s_mov_b32 s15, 0x20000
    s_and_b32 s28, s3, 3
    v_lshlrev_b32 v1, 4, v0
    v_xor_b32 v2, 32, v1
    v_xor_b32 v3, 64, v1
    v_xor_b32 v4, 96, v1
    v_xor_b32 v5, 128, v1
    v_xor_b32 v6, 160, v1
    v_xor_b32 v7, 192, v1
    v_xor_b32 v8, 224, v1

    s_lshl_b32 s26, s3, 15

    s_mov_b32 s18, 0x1000000
    s_mov_b32 s19, 0x20000
    s_waitcnt lgkmcnt(0)

    s_mov_b32 s16, s76
    s_mov_b32 s17, s77
    s_mov_b64 s[12:13], s[90:91]
    s_load_dword s24, s[12:13], 0x0

    s_mov_b32 s20, s82
    s_mov_b32 s21, s83
    s_mov_b32 s22, 0x400000
    s_mov_b32 s23, 0x20000
    s_lshl_b32 s29, s6, 20
    s_lshl_b32 s93, s28, 15
    s_add_u32 s29, s29, s93
    s_lshl_b32 s93, s5, 8
    s_add_u32 s29, s29, s93
    s_mov_b32 s30, 0x05040100
    s_mov_b32 s31, 0x07060302

    v_lshrrev_b32 v12, 4, v0
    v_and_b32 v13, 15, v0
    v_lshlrev_b32 v11, 4, v13
    v_lshl_add_u32 v15, v12, 13, v11
    v_lshl_add_u32 v9, v12, 8, v11
    v_add_u32 v11, 0x22000, v11
    s_lshl_b32 s27, s3, 2
    v_add_u32 v10, s27, v11
    s_lshl_b32 s27, s3, 11
    s_add_u32 s27, s27, 0x20000
    v_add_u32 v14, s27, v1
    s_mov_b32 s98, 0x3e0293ee

    s_waitcnt vmcnt(1)
    buffer_load_dwordx4 v3, s[16:19], s25 offen offset:2048 nt lds
    s_waitcnt vmcnt(1)
    buffer_load_dwordx4 v4, s[16:19], s25 offen offset:3072 nt lds
    s_xor_b32 s25, s25, 0x41000
    s_add_u32 s26, s26, 4096
    s_mov_b32 m0, s26
    s_nop 0
    buffer_load_dwordx4 v5, s[16:19], s25 offen offset:0 nt lds
    s_waitcnt vmcnt(2)
    buffer_load_dwordx4 v6, s[16:19], s25 offen offset:1024 nt lds
    buffer_load_dwordx4 v7, s[16:19], s25 offen offset:2048 nt lds
    buffer_load_dwordx4 v8, s[16:19], s25 offen offset:3072 nt lds
    s_xor_b32 s25, s25, 0xc3000
    s_add_u32 s26, s26, 4096
    s_mov_b32 m0, s26
    s_waitcnt vmcnt(4)
    buffer_load_dwordx4 v1, s[16:19], s25 offen offset:0 nt lds
    buffer_load_dwordx4 v2, s[16:19], s25 offen offset:1024 nt lds
    buffer_load_dwordx4 v3, s[16:19], s25 offen offset:2048 nt lds
    buffer_load_dwordx4 v4, s[16:19], s25 offen offset:3072 nt lds
    s_xor_b32 s25, s25, 0x41000
    s_add_u32 s26, s26, 4096
    s_mov_b32 m0, s26
    s_waitcnt vmcnt(7)
    buffer_load_dwordx4 v5, s[16:19], s25 offen offset:0 nt lds
    s_waitcnt vmcnt(7)
    buffer_load_dwordx4 v6, s[16:19], s25 offen offset:1024 nt lds
    s_waitcnt vmcnt(7)
    buffer_load_dwordx4 v7, s[16:19], s25 offen offset:2048 nt lds
    s_waitcnt vmcnt(7)
    buffer_load_dwordx4 v8, s[16:19], s25 offen offset:3072 nt lds
    s_xor_b32 s25, s25, 0x1c7000
    s_add_u32 s26, s26, 4096
    s_mov_b32 m0, s26
    s_waitcnt vmcnt(7)
    buffer_load_dwordx4 v1, s[16:19], s25 offen offset:0 nt lds
    s_waitcnt vmcnt(7)
    buffer_load_dwordx4 v2, s[16:19], s25 offen offset:1024 nt lds
    s_waitcnt vmcnt(7)
    buffer_load_dwordx4 v3, s[16:19], s25 offen offset:2048 nt lds
    s_waitcnt vmcnt(7)
    buffer_load_dwordx4 v4, s[16:19], s25 offen offset:3072 nt lds
    s_xor_b32 s25, s25, 0x41000
    s_add_u32 s26, s26, 4096
    s_mov_b32 m0, s26
    s_waitcnt vmcnt(7)
    buffer_load_dwordx4 v5, s[16:19], s25 offen offset:0 nt lds
    s_waitcnt vmcnt(7)
    buffer_load_dwordx4 v6, s[16:19], s25 offen offset:1024 nt lds
    s_waitcnt vmcnt(7)
    buffer_load_dwordx4 v7, s[16:19], s25 offen offset:2048 nt lds
    s_waitcnt vmcnt(7)
    buffer_load_dwordx4 v8, s[16:19], s25 offen offset:3072 nt lds
    s_xor_b32 s25, s25, 0xc3000
    s_add_u32 s26, s26, 4096
    s_mov_b32 m0, s26
    s_waitcnt vmcnt(7)
    buffer_load_dwordx4 v1, s[16:19], s25 offen offset:0 nt lds
    s_waitcnt vmcnt(7)
    buffer_load_dwordx4 v2, s[16:19], s25 offen offset:1024 nt lds
    s_waitcnt vmcnt(7)
    buffer_load_dwordx4 v3, s[16:19], s25 offen offset:2048 nt lds
    s_waitcnt vmcnt(7)
    buffer_load_dwordx4 v4, s[16:19], s25 offen offset:3072 nt lds
    s_xor_b32 s25, s25, 0x41000
    s_add_u32 s26, s26, 4096
    s_mov_b32 m0, s26
    s_waitcnt vmcnt(7)
    buffer_load_dwordx4 v5, s[16:19], s25 offen offset:0 nt lds
    s_waitcnt vmcnt(7)
    buffer_load_dwordx4 v6, s[16:19], s25 offen offset:1024 nt lds
    s_barrier
    s_waitcnt vmcnt(7)
    buffer_load_dwordx4 v7, s[16:19], s25 offen offset:2048 nt lds
    s_waitcnt vmcnt(7)
    buffer_load_dwordx4 v8, s[16:19], s25 offen offset:3072 nt lds
    s_waitcnt lgkmcnt(0)
    s_add_u32 s24, s24, 0x01010101
    s_and_b32 s8, s24, 0xff
    s_bfe_u32 s9, s24, 0x80008
    s_bfe_u32 s10, s24, 0x80010
    s_lshr_b32 s11, s24, 24

    v_and_b32 v5, 7, v0
    v_lshlrev_b32 v5, 1, v5
    v_xor_b32 v5, v5, v12
    v_lshlrev_b32 v5, 4, v5
    v_lshl_add_u32 v5, v13, 10, v5
    s_lshl_b32 s26, s3, 15
    v_add_u32 v1, s26, v5
    v_xor_b32 v2, 64, v1
    v_xor_b32 v3, 128, v1
    v_xor_b32 v4, 192, v1
    v_add_u32 v5, 0x20000, v5
    v_xor_b32 v6, 64, v5
    v_xor_b32 v7, 128, v5
    v_xor_b32 v8, 192, v5

    ds_read_b128 v[128:131], v1 offset:0
    ds_read_b128 v[132:135], v2 offset:0
    ds_read_b128 v[136:139], v3 offset:0
    ds_read_b128 v[140:143], v4 offset:0
    ds_read_b128 v[144:147], v1 offset:256
    ds_read_b128 v[148:151], v2 offset:256
    ds_read_b128 v[152:155], v3 offset:256
    ds_read_b128 v[156:159], v4 offset:256
    ds_read_b128 v[160:163], v1 offset:512
    ds_read_b128 v[164:167], v2 offset:512
    ds_read_b128 v[168:171], v3 offset:512
    ds_read_b128 v[172:175], v4 offset:512
    ds_read_b128 v[176:179], v1 offset:768
    ds_read_b128 v[180:183], v2 offset:768
    ds_read_b128 v[184:187], v3 offset:768
    ds_read_b128 v[188:191], v4 offset:768
    s_waitcnt vmcnt(6)
    s_barrier
    s_waitcnt vmcnt(0)
    s_barrier
    buffer_load_dwordx4 v[32:35], v15, s[20:23], s29 offen nt
    s_add_u32 s29, s29, 131072
    buffer_load_dwordx4 v[36:39], v15, s[20:23], s29 offen nt
    s_add_u32 s29, s29, 131072
    buffer_load_dwordx4 v[40:43], v15, s[20:23], s29 offen nt
    s_add_u32 s29, s29, 131072
    buffer_load_dwordx4 v[44:47], v15, s[20:23], s29 offen nt
    s_add_u32 s29, s29, 131072
    ds_read_b128 v[192:195], v1 offset:16384
    ds_read_b128 v[196:199], v2 offset:16384
    ds_read_b128 v[200:203], v3 offset:16384
    ds_read_b128 v[204:207], v4 offset:16384
    ds_read_b128 v[208:211], v1 offset:16640
    ds_read_b128 v[212:215], v2 offset:16640
    ds_read_b128 v[216:219], v3 offset:16640
    ds_read_b128 v[220:223], v4 offset:16640
    ds_read_b128 v[224:227], v1 offset:16896
    ds_read_b128 v[228:231], v2 offset:16896
    ds_read_b128 v[232:235], v3 offset:16896
    ds_read_b128 v[236:239], v4 offset:16896
    ds_read_b128 v[240:243], v1 offset:17152
    ds_read_b128 v[244:247], v2 offset:17152
    ds_read_b128 v[248:251], v3 offset:17152
    ds_read_b128 v[252:255], v4 offset:17152
    s_setprio 2
    s_barrier
    ds_read_b128 v[64:67], v5 offset:0
    ds_read_b128 v[68:71], v6 offset:0
    ds_read_b128 v[72:75], v7 offset:0
    ds_read_b128 v[76:79], v8 offset:0
    ds_read_b128 v[80:83], v5 offset:256
    ds_read_b128 v[84:87], v6 offset:256
    ds_read_b128 v[88:91], v7 offset:256
    ds_read_b128 v[92:95], v8 offset:256
    buffer_load_dwordx4 v[48:51], v15, s[20:23], s29 offen nt
    s_add_u32 s29, s29, 131072
    buffer_load_dwordx4 v[52:55], v15, s[20:23], s29 offen nt
    s_add_u32 s29, s29, 131072
    buffer_load_dwordx4 v[56:59], v15, s[20:23], s29 offen nt
    s_add_u32 s29, s29, 131072
    buffer_load_dwordx4 v[60:63], v15, s[20:23], s29 offen nt
    s_waitcnt lgkmcnt(6)
    v_mfma_f32_16x16x32_bf16 v[16:19], v[128:131], v[64:67], 0
    ds_read_b128 v[96:99], v5 offset:512
    v_mfma_f32_16x16x32_bf16 v[20:23], v[192:195], v[64:67], 0
    ds_read_b128 v[100:103], v6 offset:512
    v_mfma_f32_16x16x32_bf16 v[16:19], v[132:135], v[68:71], v[16:19]
    ds_read_b128 v[104:107], v7 offset:512
    v_mfma_f32_16x16x32_bf16 v[20:23], v[196:199], v[68:71], v[20:23]
    ds_read_b128 v[108:111], v8 offset:512
    s_waitcnt lgkmcnt(8)
    v_mfma_f32_16x16x32_bf16 v[16:19], v[136:139], v[72:75], v[16:19]
    ds_read_b128 v[112:115], v5 offset:768
    v_mfma_f32_16x16x32_bf16 v[20:23], v[200:203], v[72:75], v[20:23]
    ds_read_b128 v[116:119], v6 offset:768
    v_mfma_f32_16x16x32_bf16 v[16:19], v[140:143], v[76:79], v[16:19]
    ds_read_b128 v[120:123], v7 offset:768
    v_mfma_f32_16x16x32_bf16 v[20:23], v[204:207], v[76:79], v[20:23]
    ds_read_b128 v[124:127], v8 offset:768
    s_waitcnt lgkmcnt(10)
    v_mfma_f32_16x16x32_bf16 v[16:19], v[144:147], v[80:83], v[16:19]
    ds_read_b128 v[64:67], v5 offset:16384
    v_mfma_f32_16x16x32_bf16 v[20:23], v[208:211], v[80:83], v[20:23]
    ds_read_b128 v[68:71], v6 offset:16384
    v_mfma_f32_16x16x32_bf16 v[16:19], v[148:151], v[84:87], v[16:19]
    ds_read_b128 v[72:75], v7 offset:16384
    v_mfma_f32_16x16x32_bf16 v[20:23], v[212:215], v[84:87], v[20:23]
    ds_read_b128 v[76:79], v8 offset:16384
    s_waitcnt lgkmcnt(12)
    v_mfma_f32_16x16x32_bf16 v[16:19], v[152:155], v[88:91], v[16:19]
    ds_read_b128 v[80:83], v5 offset:16640
    v_mfma_f32_16x16x32_bf16 v[20:23], v[216:219], v[88:91], v[20:23]
    ds_read_b128 v[84:87], v6 offset:16640
    v_mfma_f32_16x16x32_bf16 v[16:19], v[156:159], v[92:95], v[16:19]
    ds_read_b128 v[88:91], v7 offset:16640
    v_mfma_f32_16x16x32_bf16 v[20:23], v[220:223], v[92:95], v[20:23]
    s_waitcnt lgkmcnt(13)
    v_mfma_f32_16x16x32_bf16 v[16:19], v[160:163], v[96:99], v[16:19]
    ds_read_b128 v[92:95], v8 offset:16640
    v_mfma_f32_16x16x32_bf16 v[20:23], v[224:227], v[96:99], v[20:23]
    v_mfma_f32_16x16x32_bf16 v[16:19], v[164:167], v[100:103], v[16:19]
    ds_read_b128 v[96:99], v5 offset:16896
    v_mfma_f32_16x16x32_bf16 v[20:23], v[228:231], v[100:103], v[20:23]
    s_waitcnt lgkmcnt(13)
    v_mfma_f32_16x16x32_bf16 v[16:19], v[168:171], v[104:107], v[16:19]
    ds_read_b128 v[100:103], v6 offset:16896
    v_mfma_f32_16x16x32_bf16 v[20:23], v[232:235], v[104:107], v[20:23]
    v_mfma_f32_16x16x32_bf16 v[16:19], v[172:175], v[108:111], v[16:19]
    ds_read_b128 v[104:107], v7 offset:16896
    v_mfma_f32_16x16x32_bf16 v[20:23], v[236:239], v[108:111], v[20:23]
    s_waitcnt lgkmcnt(13)
    v_mfma_f32_16x16x32_bf16 v[16:19], v[176:179], v[112:115], v[16:19]
    ds_read_b128 v[108:111], v8 offset:16896
    v_mfma_f32_16x16x32_bf16 v[20:23], v[240:243], v[112:115], v[20:23]
    v_mfma_f32_16x16x32_bf16 v[16:19], v[180:183], v[116:119], v[16:19]
    ds_read_b128 v[112:115], v5 offset:17152
    v_mfma_f32_16x16x32_bf16 v[20:23], v[244:247], v[116:119], v[20:23]
    s_waitcnt lgkmcnt(13)
    v_mfma_f32_16x16x32_bf16 v[16:19], v[184:187], v[120:123], v[16:19]
    ds_read_b128 v[116:119], v6 offset:17152
    v_mfma_f32_16x16x32_bf16 v[20:23], v[248:251], v[120:123], v[20:23]
    v_mfma_f32_16x16x32_bf16 v[16:19], v[188:191], v[124:127], v[16:19]
    ds_read_b128 v[120:123], v7 offset:17152
    v_mfma_f32_16x16x32_bf16 v[20:23], v[252:255], v[124:127], v[20:23]
    s_waitcnt lgkmcnt(13)
    v_mfma_f32_16x16x32_bf16 v[24:27], v[128:131], v[64:67], 0
    ds_read_b128 v[124:127], v8 offset:17152
    v_mfma_f32_16x16x32_bf16 v[28:31], v[192:195], v[64:67], 0
    s_nop 1
    v_max3_f32 v12, v16, v17, v18
    s_nop 0
    v_max3_f32 v13, v20, v21, v22
    v_mfma_f32_16x16x32_bf16 v[24:27], v[132:135], v[68:71], v[24:27]
    v_max3_f32 v12, v12, v19, v23
    v_max_f32 v12, v12, v13
    v_mfma_f32_16x16x32_bf16 v[28:31], v[196:199], v[68:71], v[28:31]
    v_mov_b32 v13, v12
    s_nop 1
    v_permlane32_swap_b32 v12, v13
    s_waitcnt lgkmcnt(12)
    v_mfma_f32_16x16x32_bf16 v[24:27], v[136:139], v[72:75], v[24:27]
    v_max_f32 v12, v12, v13
    v_mov_b32 v13, v12
    v_mfma_f32_16x16x32_bf16 v[28:31], v[200:203], v[72:75], v[28:31]
    s_nop 0
    v_permlane16_swap_b32 v12, v13
    v_max_f32 v12, v12, v13
    v_mfma_f32_16x16x32_bf16 v[24:27], v[140:143], v[76:79], v[24:27]
    ds_write_b32 v10, v12 offset:0
    v_mfma_f32_16x16x32_bf16 v[28:31], v[204:207], v[76:79], v[28:31]
    s_waitcnt lgkmcnt(11)
    v_mfma_f32_16x16x32_bf16 v[24:27], v[144:147], v[80:83], v[24:27]
    s_waitcnt lgkmcnt(0)
    s_barrier
    v_mfma_f32_16x16x32_bf16 v[28:31], v[208:211], v[80:83], v[28:31]
    ds_read_b128 v[64:67], v11 offset:0
    v_mfma_f32_16x16x32_bf16 v[24:27], v[148:151], v[84:87], v[24:27]
    v_mfma_f32_16x16x32_bf16 v[28:31], v[212:215], v[84:87], v[28:31]
    v_mfma_f32_16x16x32_bf16 v[24:27], v[152:155], v[88:91], v[24:27]
    s_waitcnt lgkmcnt(0)
    v_max3_f32 v12, v64, v65, v66
    v_mfma_f32_16x16x32_bf16 v[28:31], v[216:219], v[88:91], v[28:31]
    v_max_f32 v12, v12, v67
    v_mul_f32 v12, s98, v12
    v_mfma_f32_16x16x32_bf16 v[24:27], v[156:159], v[92:95], v[24:27]
    v_fma_f32 v16, v16, s98, -v12
    v_fma_f32 v17, v17, s98, -v12
    v_mfma_f32_16x16x32_bf16 v[28:31], v[220:223], v[92:95], v[28:31]
    v_fma_f32 v18, v18, s98, -v12
    v_fma_f32 v19, v19, s98, -v12
    v_mfma_f32_16x16x32_bf16 v[24:27], v[160:163], v[96:99], v[24:27]
    v_fma_f32 v20, v20, s98, -v12
    v_fma_f32 v21, v21, s98, -v12
    v_mfma_f32_16x16x32_bf16 v[28:31], v[224:227], v[96:99], v[28:31]
    v_fma_f32 v22, v22, s98, -v12
    v_fma_f32 v23, v23, s98, -v12
    v_mfma_f32_16x16x32_bf16 v[24:27], v[164:167], v[100:103], v[24:27]
    v_exp_f32 v16, v16
    v_mfma_f32_16x16x32_bf16 v[28:31], v[228:231], v[100:103], v[28:31]
    v_exp_f32 v17, v17
    v_mfma_f32_16x16x32_bf16 v[24:27], v[168:171], v[104:107], v[24:27]
    v_exp_f32 v18, v18
    v_mfma_f32_16x16x32_bf16 v[28:31], v[232:235], v[104:107], v[28:31]
    v_exp_f32 v19, v19
    v_mfma_f32_16x16x32_bf16 v[24:27], v[172:175], v[108:111], v[24:27]
    v_exp_f32 v20, v20
    v_mfma_f32_16x16x32_bf16 v[28:31], v[236:239], v[108:111], v[28:31]
    v_exp_f32 v21, v21
    v_mfma_f32_16x16x32_bf16 v[24:27], v[176:179], v[112:115], v[24:27]
    v_exp_f32 v22, v22
    v_mfma_f32_16x16x32_bf16 v[28:31], v[240:243], v[112:115], v[28:31]
    v_exp_f32 v23, v23
    v_mfma_f32_16x16x32_bf16 v[24:27], v[180:183], v[116:119], v[24:27]
    v_cvt_pk_bf16_f32 v64, v16, v17
    v_cvt_pk_bf16_f32 v65, v18, v19
    v_mfma_f32_16x16x32_bf16 v[28:31], v[244:247], v[116:119], v[28:31]
    v_cvt_pk_bf16_f32 v66, v20, v21
    v_cvt_pk_bf16_f32 v67, v22, v23
    v_mfma_f32_16x16x32_bf16 v[24:27], v[184:187], v[120:123], v[24:27]
    ds_write_b128 v14, v[64:67] offset:0
    v_mfma_f32_16x16x32_bf16 v[28:31], v[248:251], v[120:123], v[28:31]
    v_mfma_f32_16x16x32_bf16 v[24:27], v[188:191], v[124:127], v[24:27]
    s_waitcnt lgkmcnt(0)
    s_barrier
    v_mfma_f32_16x16x32_bf16 v[28:31], v[252:255], v[124:127], v[28:31]
    s_nop 4
    v_max3_f32 v12, v24, v25, v26
    s_nop 1
    v_max3_f32 v13, v28, v29, v30
    v_max3_f32 v12, v12, v27, v31
    v_max_f32 v12, v12, v13
    v_mov_b32 v13, v12
    s_nop 1
    v_permlane32_swap_b32 v12, v13
    v_max_f32 v12, v12, v13
    v_mov_b32 v13, v12
    s_nop 1
    v_permlane16_swap_b32 v12, v13
    v_max_f32 v12, v12, v13
    ds_write_b32 v10, v12 offset:256
    s_waitcnt lgkmcnt(0)
    s_barrier
    ds_read_b128 v[64:67], v11 offset:256
    s_waitcnt lgkmcnt(0)
    v_max3_f32 v12, v64, v65, v66
    v_max_f32 v12, v12, v67
    v_mul_f32 v12, s98, v12
    v_fma_f32 v24, v24, s98, -v12
    v_fma_f32 v25, v25, s98, -v12
    v_fma_f32 v26, v26, s98, -v12
    v_fma_f32 v27, v27, s98, -v12
    v_fma_f32 v28, v28, s98, -v12
    v_fma_f32 v29, v29, s98, -v12
    v_fma_f32 v30, v30, s98, -v12
    v_fma_f32 v31, v31, s98, -v12
    v_exp_f32 v24, v24
    v_exp_f32 v25, v25
    v_exp_f32 v26, v26
    v_exp_f32 v27, v27
    v_exp_f32 v28, v28
    v_exp_f32 v29, v29
    v_exp_f32 v30, v30
    v_exp_f32 v31, v31
    v_cvt_pk_bf16_f32 v64, v24, v25
    v_cvt_pk_bf16_f32 v65, v26, v27
    v_cvt_pk_bf16_f32 v66, v28, v29
    v_cvt_pk_bf16_f32 v67, v30, v31
    ds_write_b128 v14, v[64:67] offset:1024
    s_waitcnt lgkmcnt(0)
    s_barrier
    s_setprio 2

    v_lshlrev_b32 v5, 4, v0
    s_cmp_lt_u32 s28, 2
    s_cbranch_scc0 L_U2s
    s_lshl_b32 s92, s28, 8
    v_add_u32 v64, s92, v11
    s_lshl_b32 s92, s28, 10
    s_add_u32 s92, s92, 0x20000
    v_add_u32 v65, s92, v5
    ds_read_b128 v[72:75], v64

    ds_read_b128 v[76:79], v65 offset:0
    ds_read_b128 v[80:83], v65 offset:2048
    ds_read_b128 v[84:87], v65 offset:4096
    ds_read_b128 v[88:91], v65 offset:6144
    v_lshrrev_b32 v66, 2, v0
    v_lshlrev_b32 v66, 13, v66
    v_and_or_b32 v66, v5, 48, v66
    s_lshl_b32 s96, s4, 6
    s_lshl_b32 s93, s28, 15
    s_add_u32 s96, s96, s93
    s_add_u32 s96, s96, 0x10000

    v_mov_b32 v70, s24
    v_mov_b32 v71, s24
    s_mov_b32 s97, 0x3f803f80
    v_mov_b32 v69, 0
    s_waitcnt lgkmcnt(4)
    v_max3_f32 v68, v72, v73, v74
    v_max_f32 v68, v68, v75
    v_mul_f32 v68, s98, v68
    s_waitcnt lgkmcnt(0)

    v_dot2c_f32_bf16 v69, s97, v76
    v_dot2c_f32_bf16 v69, s97, v77
    v_dot2c_f32_bf16 v69, s97, v78
    v_dot2c_f32_bf16 v69, s97, v79
    v_dot2c_f32_bf16 v69, s97, v80
    v_dot2c_f32_bf16 v69, s97, v81
    v_dot2c_f32_bf16 v69, s97, v82
    v_dot2c_f32_bf16 v69, s97, v83
    v_dot2c_f32_bf16 v69, s97, v84
    v_dot2c_f32_bf16 v69, s97, v85
    v_dot2c_f32_bf16 v69, s97, v86
    v_dot2c_f32_bf16 v69, s97, v87
    v_dot2c_f32_bf16 v69, s97, v88
    v_dot2c_f32_bf16 v69, s97, v89
    v_dot2c_f32_bf16 v69, s97, v90
    v_dot2c_f32_bf16 v69, s97, v91
    s_nop 2
    v_mov_b32 v72, v69
    s_nop 1
    v_permlane32_swap_b32 v69, v72
    v_add_f32 v69, v69, v72
    v_mov_b32 v72, v69
    s_nop 1
    v_permlane16_swap_b32 v69, v72
    v_add_f32 v69, v69, v72

    s_mov_b64 exec, 0xffff
    buffer_store_dwordx4 v[68:71], v66, s[12:15], s96 offen sc1
    s_mov_b64 exec, -1
L_U2s:

    s_setprio 0
    s_and_b32 s92, s2, 7
    s_lshl_b32 s92, s92, 5

    v_and_b32 v22, 7, v0
    v_lshl_add_u32 v22, v22, 2, s92
    global_load_dword v22, v22, s[88:89] sc1

    v_lshrrev_b32 v12, 4, v0
    v_and_b32 v13, 15, v0
    v_lshrrev_b32 v14, 2, v13
    v_lshlrev_b32 v10, 4, v13
    v_lshl_add_u32 v1, v12, 11, v10
    v_and_b32 v11, 3, v0
    v_lshl_add_u32 v11, v12, 2, v11
    v_lshlrev_b32 v11, 7, v11
    s_mul_i32 s92, s28, 320
    s_add_u32 s92, s92, 0x23000
    v_add_u32 v2, s92, v10
    s_lshl_b32 s92, s28, 6
    s_add_u32 s92, s92, 0x23000
    v_lshl_add_u32 v7, v12, 4, s92
    v_lshl_add_u32 v7, v14, 8, v7
    s_lshl_b32 s92, s28, 11
    s_add_u32 s92, s92, 0x24000
    v_add_u32 v3, s92, v5
    s_lshr_b32 s26, s4, 4
    s_and_b32 s27, s5, 3
    v_mov_b32 v20, 1.0
    v_mov_b32 v21, 0
    s_mov_b32 s94, 4
    s_mov_b32 s18, 0x400000

    s_mov_b32 s16, s84
    s_mov_b32 s17, s85
    s_lshl_b32 s100, s26, 13
    s_lshl_b32 s93, s27, 4
    s_add_u32 s100, s100, s93
    s_lshl_b32 s93, s28, 11
    s_add_u32 s100, s100, s93
    s_add_u32 s100, s100, 0x10000
    s_mul_i32 s92, s4, 34048
    s_lshl_b32 s101, s92, 0
    s_lshl_b32 s93, s28, 13
    s_add_u32 s101, s101, s93
    s_add_u32 s101, s101, 0x402000
    s_add_u32 s81, s101, 4096
    s_lshl_b32 s98, s5, 13
    s_lshl_b32 s93, s28, 11
    s_add_u32 s98, s98, s93
    s_lshl_b32 s93, s6, 8
    s_add_u32 s98, s98, s93
    s_add_u32 s98, s98, 0x100000
    s_add_u32 s29, s98, 0x200000
    v_mul_u32_u24 v224, 33, v14
    v_and_b32 v225, 3, v0
    v_lshl_add_u32 v224, v225, 2, v224
    v_lshlrev_b32 v224, 4, v224
    v_lshl_add_u32 v224, v12, 11, v224
    s_lshl_b32 s92, s28, 13
    v_add_u32 v224, s92, v224
    v_xor_b32 v225, 16, v224
    v_xor_b32 v226, 32, v224
    v_xor_b32 v227, 48, v224
    v_xor_b32 v228, s28, v13
    v_lshlrev_b32 v228, 4, v228
    v_lshl_add_u32 v228, v12, 11, v228
    s_lshl_b32 s92, s28, 9
    v_add_u32 v228, s92, v228
    v_and_b32 v231, 1, v0
    v_cmp_eq_u32 vcc, 1, v231
    v_lshlrev_b32 v229, 3, v231
    v_lshl_add_u32 v229, v14, 4, v229
    v_lshl_add_u32 v229, v12, 6, v229
    v_bfe_u32 v231, v0, 1, 1
    v_lshl_add_u32 v229, v231, 10, v229
    v_mov_b32 v230, s8
    v_mov_b32 v231, s9
    v_mov_b32 v232, s10
    v_mov_b32 v233, s11
    v_cndmask_b32 v230, v230, v232, vcc
    v_cndmask_b32 v231, v231, v233, vcc
    v_mov_b32 v232, 0xffffff00
    v_mul_u32_u24 v7, 320, v14
    v_lshl_add_u32 v7, v12, 4, v7
    v_add_u32 v7, 0x23000, v7
    v_add_u32 v3, 0x2000, v3
    s_and_b32 s92, s5, 3
    s_andn2_b32 s5, s5, 3
    s_or_b32 s5, s5, s6
    s_xor_b32 s6, s92, 3
    s_lshl_b32 s25, s5, 17
    s_lshl_b32 s93, s28, 15
    s_add_u32 s25, s25, s93
    s_lshl_b32 s93, s6, 8
    s_add_u32 s25, s25, s93
    s_lshl_b32 s99, s5, 13
    s_lshl_b32 s93, s28, 11
    s_add_u32 s99, s99, s93
    s_add_u32 s99, s99, 0x100000
    s_lshl_b32 s80, s26, 10
    s_lshl_b32 s93, s28, 8
    s_add_u32 s80, s80, s93
    s_add_u32 s80, s80, 0xa000
    v_lshlrev_b32 v6, 7, v0
    v_and_b32 v23, 3, v0
    v_lshlrev_b32 v23, 3, v23
    v_lshrrev_b32 v23, v23, s24
    v_lshlrev_b32 v24, 15, v23
    v_and_b32 v23, 0x55, v23
    v_and_b32 v24, 0x550000, v24
    v_or_b32 v23, v23, v24
    v_and_b32 v28, 0x10001, v23
    v_lshrrev_b32 v23, 2, v23
    v_and_b32 v29, 0x10001, v23
    v_lshrrev_b32 v23, 2, v23
    v_and_b32 v30, 0x10001, v23
    v_lshrrev_b32 v23, 2, v23
    v_and_b32 v31, 0x10001, v23
    s_waitcnt vmcnt(0)
    s_getreg_b32 s95, hwreg(HW_REG_XCC_ID, 0, 4)
    s_add_u32 s95, s95, 1
    s_mul_i32 s95, s95, 0x01010101
    v_cmp_ne_u32 vcc, s95, v22
    s_nop 1
    s_cmp_eq_u64 vcc, 0
    s_cselect_b32 s95, 0, 0x200000
    v_perm_b32 v128, v36, v32, s30
    v_perm_b32 v129, v44, v40, s30
    v_perm_b32 v130, v52, v48, s30
    v_perm_b32 v131, v60, v56, s30
    ds_write_b128 v224, v[128:131] offset:0
    v_perm_b32 v132, v36, v32, s31
    v_perm_b32 v133, v44, v40, s31
    v_perm_b32 v134, v52, v48, s31
    v_perm_b32 v135, v60, v56, s31
    ds_write_b128 v224, v[132:135] offset:256
    v_perm_b32 v136, v37, v33, s30
    v_perm_b32 v137, v45, v41, s30
    v_perm_b32 v138, v53, v49, s30
    v_perm_b32 v139, v61, v57, s30
    ds_write_b128 v225, v[136:139] offset:0
    v_perm_b32 v140, v37, v33, s31
    v_perm_b32 v141, v45, v41, s31
    v_perm_b32 v142, v53, v49, s31
    v_perm_b32 v143, v61, v57, s31
    ds_write_b128 v225, v[140:143] offset:256
    v_perm_b32 v144, v38, v34, s30
    v_perm_b32 v145, v46, v42, s30
    v_perm_b32 v146, v54, v50, s30
    v_perm_b32 v147, v62, v58, s30
    ds_write_b128 v226, v[144:147] offset:0
    v_perm_b32 v148, v38, v34, s31
    v_perm_b32 v149, v46, v42, s31
    v_perm_b32 v150, v54, v50, s31
    v_perm_b32 v151, v62, v58, s31
    ds_write_b128 v226, v[148:151] offset:256
    v_perm_b32 v152, v39, v35, s30
    v_perm_b32 v153, v47, v43, s30
    v_perm_b32 v154, v55, v51, s30
    v_perm_b32 v155, v63, v59, s30
    ds_write_b128 v227, v[152:155] offset:0
    v_perm_b32 v156, v39, v35, s31
    v_perm_b32 v157, v47, v43, s31
    v_perm_b32 v158, v55, v51, s31
    v_perm_b32 v159, v63, v59, s31
    ds_write_b128 v227, v[156:159] offset:256
    s_mov_b32 s96, 0x000f000f
    s_mov_b32 s97, 0x000f000f
    s_mov_b32 s7, 0
    s_waitcnt lgkmcnt(0)
    s_barrier
    ds_read_b128 v[128:131], v228 offset:0
    ds_read_b128 v[132:135], v228 offset:256
    ds_read_b128 v[136:139], v228 offset:8192
    ds_read_b128 v[140:143], v228 offset:8448
    ds_read_b128 v[144:147], v228 offset:16384
    ds_read_b128 v[148:151], v228 offset:16640
    ds_read_b128 v[152:155], v228 offset:24576
    ds_read_b128 v[156:159], v228 offset:24832
    s_mov_b64 exec, 3
L_of:
    v_mov_b32 v8, 0
    buffer_atomic_or v8, v6, s[12:15], s80 offen sc0 sc1
    s_waitcnt vmcnt(0)
    v_xor_b32 v8, s24, v8
    v_cmp_ne_u32 vcc, 0, v8
    s_add_u32 s7, s7, 1
    s_cmp_lt_u32 s7, 20000
    s_cselect_b64 vcc, vcc, 0
    s_cbranch_vccnz L_of
    s_mov_b64 exec, -1
    s_mov_b32 s7, 0
    s_mov_b64 exec, s[96:97]
    buffer_load_dwordx4 v[12:15], v11, s[12:15], s100 offen sc1
    buffer_load_dwordx4 v[16:19], v11, s[12:15], s100 offen offset:64 sc1
    s_mov_b64 exec, -1
    buffer_load_dwordx4 v[96:99], v9, s[12:15], s101 offen offset:0 sc1
    buffer_load_dwordx4 v[100:103], v9, s[12:15], s101 offen offset:1024 sc1
    buffer_load_dwordx4 v[104:107], v9, s[12:15], s101 offen offset:2048 sc1
    buffer_load_dwordx4 v[108:111], v9, s[12:15], s101 offen offset:3072 sc1
    buffer_load_dwordx4 v[112:115], v9, s[12:15], s81 offen offset:0 sc1
    buffer_load_dwordx4 v[116:119], v9, s[12:15], s81 offen offset:1024 sc1
    buffer_load_dwordx4 v[120:123], v9, s[12:15], s81 offen offset:2048 sc1
    buffer_load_dwordx4 v[124:127], v9, s[12:15], s81 offen offset:3072 sc1
    s_mov_b64 s[82:83], -1
    s_barrier
    s_waitcnt vmcnt(8)
    v_max_f32 v8, v12, v16
    v_xor_b32 v21, s24, v14
    v_bitop3_b32 v21, v15, s24, v21 bitop3:0xbe
    v_max_f32_dpp v8, v8, v8 quad_perm:[1,0,3,2] row_mask:0xf bank_mask:0xf
    v_bitop3_b32 v21, v18, s24, v21 bitop3:0xbe
    v_bitop3_b32 v21, v19, s24, v21 bitop3:0xbe
    v_max_f32_dpp v8, v8, v8 quad_perm:[2,3,0,1] row_mask:0xf bank_mask:0xf
    v_mov_b32 v22, v8
    v_cmp_ne_u32 s[92:93], 0, v21
    s_waitcnt vmcnt(7)
    v_xor_b32 v96, v28, v96
    v_permlane32_swap_b32 v8, v22
    v_max_f32 v8, v8, v22
    v_mov_b32 v22, v8
    v_xor_b32 v97, v29, v97
    v_xor_b32 v98, v30, v98
    v_permlane16_swap_b32 v8, v22
    v_max_f32 v8, v8, v22
    v_sub_f32 v12, v12, v8
    v_sub_f32 v16, v16, v8
    v_exp_f32 v12, v12
    v_exp_f32 v16, v16
    v_xor_b32 v99, v31, v99
    v_mul_f32 v8, v12, v13
    v_fmac_f32 v8, v16, v17
    v_or_b32 v23, v96, v97
    v_or3_b32 v23, v23, v98, v99
    v_add_f32_dpp v8, v8, v8 quad_perm:[1,0,3,2] row_mask:0xf bank_mask:0xf
    s_waitcnt vmcnt(6)
    v_xor_b32 v100, v28, v100
    v_xor_b32 v101, v29, v101
    v_add_f32_dpp v8, v8, v8 quad_perm:[2,3,0,1] row_mask:0xf bank_mask:0xf
    v_mov_b32 v22, v8
    v_xor_b32 v102, v30, v102
    v_xor_b32 v103, v31, v103
    v_permlane32_swap_b32 v8, v22
    v_add_f32 v8, v8, v22
    v_mov_b32 v22, v8
    v_or3_b32 v23, v23, v100, v101
    v_or3_b32 v23, v23, v102, v103
    v_permlane16_swap_b32 v8, v22
    v_add_f32 v8, v8, v22
    v_rcp_f32 v8, v8
    v_perm_b32 v64, v100, v96, s30
    v_mul_f32 v12, v12, v8
    v_mul_f32 v16, v16, v8
    v_cvt_pk_bf16_f32 v12, v12, v16
    v_perm_b32 v68, v100, v96, s31
    v_perm_b32 v72, v101, v97, s30
    v_mov_b32_dpp v16, v12 quad_perm:[0,0,0,0] row_mask:0xf bank_mask:0xf
    v_mov_b32_dpp v17, v12 quad_perm:[1,1,1,1] row_mask:0xf bank_mask:0xf
    v_mov_b32_dpp v18, v12 quad_perm:[2,2,2,2] row_mask:0xf bank_mask:0xf
    v_mov_b32_dpp v19, v12 quad_perm:[3,3,3,3] row_mask:0xf bank_mask:0xf
    s_and_b64 s[92:93], s[92:93], s[96:97]
    v_perm_b32 v76, v101, v97, s31
    v_perm_b32 v80, v102, v98, s30
    v_perm_b32 v84, v102, v98, s31
    v_perm_b32 v88, v103, v99, s30
    v_perm_b32 v92, v103, v99, s31
    s_waitcnt vmcnt(5)
    v_xor_b32 v104, v28, v104
    v_xor_b32 v105, v29, v105
    v_xor_b32 v106, v30, v106
    v_xor_b32 v107, v31, v107
    v_or3_b32 v23, v23, v104, v105
    v_or3_b32 v23, v23, v106, v107
    s_waitcnt vmcnt(4)
    v_xor_b32 v108, v28, v108
    v_xor_b32 v109, v29, v109
    v_xor_b32 v110, v30, v110
    v_xor_b32 v111, v31, v111
    v_or3_b32 v23, v23, v108, v109
    v_or3_b32 v23, v23, v110, v111
    v_perm_b32 v65, v108, v104, s30
    v_perm_b32 v69, v108, v104, s31
    v_perm_b32 v73, v109, v105, s30
    v_perm_b32 v77, v109, v105, s31
    v_perm_b32 v81, v110, v106, s30
    v_perm_b32 v85, v110, v106, s31
    v_perm_b32 v89, v111, v107, s30
    v_perm_b32 v93, v111, v107, s31
    s_waitcnt vmcnt(3)
    v_xor_b32 v112, v28, v112
    v_xor_b32 v113, v29, v113
    v_xor_b32 v114, v30, v114
    v_xor_b32 v115, v31, v115
    v_or3_b32 v23, v23, v112, v113
    v_or3_b32 v23, v23, v114, v115
    s_waitcnt vmcnt(2)
    v_xor_b32 v116, v28, v116
    v_xor_b32 v117, v29, v117
    v_xor_b32 v118, v30, v118
    v_xor_b32 v119, v31, v119
    v_or3_b32 v23, v23, v116, v117
    v_or3_b32 v23, v23, v118, v119
    v_perm_b32 v66, v116, v112, s30
    v_perm_b32 v70, v116, v112, s31
    v_perm_b32 v74, v117, v113, s30
    v_perm_b32 v78, v117, v113, s31
    v_perm_b32 v82, v118, v114, s30
    v_perm_b32 v86, v118, v114, s31
    v_perm_b32 v90, v119, v115, s30
    v_perm_b32 v94, v119, v115, s31
    s_waitcnt vmcnt(1)
    v_xor_b32 v120, v28, v120
    v_xor_b32 v121, v29, v121
    v_xor_b32 v122, v30, v122
    v_xor_b32 v123, v31, v123
    v_or3_b32 v23, v23, v120, v121
    v_or3_b32 v23, v23, v122, v123
    s_waitcnt vmcnt(0)
    v_xor_b32 v124, v28, v124
    v_xor_b32 v125, v29, v125
    v_xor_b32 v126, v30, v126
    v_xor_b32 v127, v31, v127
    v_or3_b32 v23, v23, v124, v125
    v_or3_b32 v23, v23, v126, v127
    v_and_b32 v23, 0x10001, v23
    v_cmp_ne_u32 vcc, 0, v23
    v_perm_b32 v67, v124, v120, s30
    v_perm_b32 v71, v124, v120, s31
    s_or_b64 vcc, vcc, s[92:93]
    s_cbranch_vccnz L_U2g
L_ook:

    v_perm_b32 v75, v125, v121, s30
    v_mfma_f32_16x16x32_bf16 v[160:163], v[16:19], v[64:67], 0
    v_perm_b32 v79, v125, v121, s31
    v_mfma_f32_16x16x32_bf16 v[164:167], v[16:19], v[68:71], 0
    v_perm_b32 v83, v126, v122, s30
    v_mfma_f32_16x16x32_bf16 v[168:171], v[16:19], v[72:75], 0
    v_perm_b32 v87, v126, v122, s31
    v_mfma_f32_16x16x32_bf16 v[172:175], v[16:19], v[76:79], 0
    v_perm_b32 v91, v127, v123, s30
    v_mfma_f32_16x16x32_bf16 v[176:179], v[16:19], v[80:83], 0
    v_perm_b32 v95, v127, v123, s31
    v_mfma_f32_16x16x32_bf16 v[180:183], v[16:19], v[84:87], 0
    v_mfma_f32_16x16x32_bf16 v[184:187], v[16:19], v[88:91], 0
    v_mfma_f32_16x16x32_bf16 v[188:191], v[16:19], v[92:95], 0
    v_cvt_pk_bf16_f32 v12, v160, v164
    s_nop 0
    v_cvt_pk_bf16_f32 v13, v168, v172
    s_nop 2
    v_cvt_pk_bf16_f32 v14, v176, v180
    s_nop 0
    v_cvt_pk_bf16_f32 v15, v184, v188

    s_mov_b64 exec, 0xffff
    ds_write_b128 v2, v[12:15]
    s_mov_b64 exec, -1

    s_mov_b32 s7, 0
    s_mov_b32 s27, s99
    s_waitcnt lgkmcnt(0)
    s_barrier
    ds_read_b128 v[240:243], v7 offset:0
    ds_read_b128 v[244:247], v7 offset:64
    ds_read_b128 v[248:251], v7 offset:128
    ds_read_b128 v[252:255], v7 offset:192
    s_cmp_eq_u32 s95, 0
    s_waitcnt lgkmcnt(3)
    v_mfma_f32_16x16x32_bf16 v[192:195], v[240:243], v[128:131], 0
    v_mfma_f32_16x16x32_bf16 v[196:199], v[240:243], v[132:135], 0
    s_waitcnt lgkmcnt(2)
    v_mfma_f32_16x16x32_bf16 v[192:195], v[244:247], v[136:139], v[192:195]
    v_mfma_f32_16x16x32_bf16 v[196:199], v[244:247], v[140:143], v[196:199]
    s_waitcnt lgkmcnt(1)
    v_mfma_f32_16x16x32_bf16 v[192:195], v[248:251], v[144:147], v[192:195]
    v_mfma_f32_16x16x32_bf16 v[196:199], v[248:251], v[148:151], v[196:199]
    s_waitcnt lgkmcnt(0)
    v_mfma_f32_16x16x32_bf16 v[192:195], v[252:255], v[152:155], v[192:195]
    v_mfma_f32_16x16x32_bf16 v[196:199], v[252:255], v[156:159], v[196:199]
    s_nop 6
    v_and_or_b32 v234, v192, v232, v230
    v_and_or_b32 v235, v196, v232, v231

    buffer_store_dwordx2 v[234:235], v229, s[12:15], s98 offen

    s_cbranch_scc1 L_U2p
    buffer_store_dwordx2 v[234:235], v229, s[12:15], s29 offen sc1
L_U2p:
    s_barrier
    s_mov_b32 s100, 1
    s_branch L_TAILb
L_BP:
    v_and_b32 v0, 63, v0
    s_lshr_b32 s5, s4, 2
    s_and_b32 s6, s4, 3
    s_mov_b32 s14, 0x10000000
    s_mov_b32 s15, 0x20000
    s_and_b32 s28, s3, 3
    s_waitcnt lgkmcnt(0)
    s_mov_b64 s[12:13], s[90:91]
    s_load_dword s24, s[12:13], 0x0
    s_cmp_eq_u32 s28, 2
    s_cbranch_scc0 Lxt_8
    s_getreg_b32 s95, hwreg(HW_REG_XCC_ID, 0, 4)
    s_and_b32 s92, s2, 7
    s_lshl_b32 s92, s92, 5
    s_lshr_b32 s93, s2, 3
    s_add_u32 s92, s92, s93
    s_add_u32 s95, s95, 1
    v_mov_b32 v40, s92
    v_mov_b32 v41, s95
    s_mov_b64 exec, 1
    global_store_byte v40, v41, s[88:89]
    global_load_ubyte v42, v40, s[88:89] sc1
    s_mov_b64 exec, -1
Lxt_8:

    s_getpc_b64 s[96:97]
Lpc_9:
    s_sub_u32 s96, s96, Lpc_9-concat_heads__sliding_block_cached__compressed_kv_cla__decode_kernel
    s_subb_u32 s97, s97, 0
    s_and_b32 s92, s4, 15
    s_lshl_b32 s92, s92, 11
    s_lshl_b32 s98, s28, 9
    s_add_u32 s92, s92, s98
    v_lshl_add_u32 v6, v0, 3, s92
    v_min_u32 v6, L_exit-concat_heads__sliding_block_cached__compressed_kv_cla__decode_kernel-4, v6
    global_load_dword v23, v6, s[96:97]

    v_lshlrev_b32 v24, 21, v0
    s_mov_b32 s92, 0x800
    s_mov_b64 exec, 0x1f
    buffer_load_dword v25, v24, s[12:15], s92 offen
    s_mov_b64 exec, -1
    s_lshr_b32 s92, s4, 5
    s_lshl_b32 s92, s92, 11
    s_add_u32 s92, s92, 1024
    s_bfe_u32 s93, s4, 0x20003
    s_lshl_b32 s93, s93, 8
    s_add_u32 s92, s92, s93
    s_and_b32 s93, s4, 2
    s_lshl_b32 s93, s93, 6
    s_add_u32 s92, s92, s93
    v_mov_b32 v56, s92
    s_cmp_eq_u32 s28, 1
    s_cselect_b64 exec, 1, 0
    global_load_dword v57, v56, s[86:87] sc1
    s_mov_b64 exec, -1
    v_lshlrev_b32 v26, 7, v0
    v_lshrrev_b32 v28, 1, v0
    v_lshlrev_b32 v28, 11, v28
    v_and_b32 v29, 0x80, v26
    v_or_b32 v28, v28, v29
    s_and_b32 s96, s4, 15
    s_lshr_b32 s97, s4, 4
    s_bfe_u32 s98, s4, 0x30001
    s_and_b32 s99, s4, 1
    s_mov_b32 exec_hi, 0
    s_lshl_b32 s92, s98, 12
    s_lshl_b32 s93, s97, 9
    s_add_u32 s92, s92, s93
    s_lshl_b32 s93, s99, 8
    s_add_u32 s92, s92, s93
    s_add_u32 s92, s92, 0x2000
    s_cmp_eq_u32 s28, 2
    s_cselect_b32 exec_lo, 3, 0
    buffer_load_dword v27, v26, s[12:15], s92 offen sc1
    s_lshl_b32 s92, s98, 10
    s_lshl_b32 s93, s97, 7
    s_add_u32 s92, s92, s93
    s_add_u32 s92, s92, 0xa000
    s_cmp_eq_u32 s28, 3
    s_cselect_b32 exec_lo, 1, 0
    buffer_load_dword v27, v26, s[12:15], s92 offen sc1
    s_mov_b64 exec, -1
    s_waitcnt lgkmcnt(0)
    s_add_u32 s24, s24, 0x01010101
    s_and_b32 s8, s24, 0xff
    s_bfe_u32 s9, s24, 0x80008
    s_bfe_u32 s10, s24, 0x80010
    s_lshr_b32 s11, s24, 24

    v_lshlrev_b32 v5, 4, v0
    s_lshr_b32 s26, s4, 4
    s_lshr_b32 s27, s4, 5

    s_lshl_b32 s96, s26, 12
    s_lshl_b32 s93, s28, 10
    s_add_u32 s96, s96, s93
    s_add_u32 s96, s96, 0x2000
    s_lshl_b32 s97, s27, 15
    s_lshl_b32 s93, s28, 13
    s_add_u32 s97, s97, s93
    s_add_u32 s97, s97, 0x20000

    s_add_u32 s98, s97, 4096
    s_lshl_b32 s92, s28, 13
    s_add_u32 s92, s92, 0x20000
    v_add_u32 v192, s92, v5

    v_xor_b32 v193, 32, v192
    v_xor_b32 v194, 64, v192
    v_xor_b32 v195, 96, v192
    v_xor_b32 v196, 128, v192
    v_xor_b32 v197, 160, v192
    v_xor_b32 v198, 192, v192
    v_xor_b32 v199, 224, v192
    v_and_b32 v60, 3, v0
    v_lshlrev_b32 v60, 3, v60
    v_lshrrev_b32 v60, v60, s24
    v_lshlrev_b32 v61, 15, v60
    v_and_b32 v60, 0x55, v60
    v_and_b32 v61, 0x550000, v61
    v_or_b32 v60, v60, v61
    v_and_b32 v48, 0x10001, v60
    v_lshrrev_b32 v60, 2, v60
    v_and_b32 v49, 0x10001, v60
    v_lshrrev_b32 v60, 2, v60
    v_and_b32 v50, 0x10001, v60
    v_lshrrev_b32 v60, 2, v60
    v_and_b32 v51, 0x10001, v60

    v_and_b32 v6, 7, v0
    v_lshlrev_b32 v6, 7, v6
    v_lshrrev_b32 v60, 4, v0
    v_and_b32 v61, 15, v0
    v_mul_u32_u24 v9, 544768, v60
    v_lshl_add_u32 v9, v61, 4, v9
    v_add_u32 v15, 0x20000, v5
    s_mov_b32 s26, 0xfffefffe
    v_lshrrev_b32 v62, 2, v0
    v_and_b32 v63, 7, v62
    v_lshlrev_b32 v63, 5, v63
    v_lshl_add_u32 v62, v62, 10, v63
    v_and_b32 v63, 3, v0
    v_lshl_add_u32 v62, v63, 3, v62
    s_lshl_b32 s27, s28, 8
    s_waitcnt vmcnt(0)
    v_add_u32 v32, s27, v62

    v_xor_b32 v33, 0x20, v32
    v_xor_b32 v34, 0x40, v32
    v_xor_b32 v35, 0x60, v32
    v_xor_b32 v36, 0x80, v32
    v_xor_b32 v37, 0xa0, v32
    v_xor_b32 v38, 0xc0, v32
    v_xor_b32 v39, 0xe0, v32
    v_xor_b32 v40, 0x10000, v32
    v_xor_b32 v41, 0x10020, v32
    v_xor_b32 v42, 0x10040, v32
    v_xor_b32 v43, 0x10060, v32
    v_xor_b32 v44, 0x10080, v32
    v_xor_b32 v45, 0x100a0, v32
    v_xor_b32 v46, 0x100c0, v32
    v_xor_b32 v47, 0x100e0, v32
    s_mul_i32 s92, s28, 34048
    s_and_b32 s99, s4, 7
    s_bfe_u32 s100, s4, 0x20003
    s_lshr_b32 s101, s4, 5
    s_lshl_b32 s64, s92, 0
    s_lshl_b32 s93, s99, 10
    s_add_u32 s64, s64, s93
    s_lshl_b32 s93, s100, 8
    s_add_u32 s64, s64, s93
    s_lshl_b32 s93, s101, 13
    s_add_u32 s64, s64, s93
    s_add_u32 s64, s64, 0x402000
    s_add_u32 s65, s64, 0x21400
    s_add_u32 s66, s64, 0x42800
    s_add_u32 s67, s64, 0x63c00
    s_add_u32 s68, s64, 0x214000
    s_add_u32 s69, s64, 0x235400
    s_add_u32 s70, s64, 0x256800
    s_add_u32 s71, s64, 0x277c00
    s_lshr_b32 s81, s4, 4
    s_lshl_b32 s80, s81, 7
    s_add_u32 s80, s80, 0x1000
    s_lshl_b32 s81, s81, 7
    s_add_u32 s81, s81, 0xa000
    v_mov_b32 v62, 1
    v_lshrrev_b32 v63, 3, v0
    v_lshlrev_b32 v63, 10, v63
    s_movk_i32 s92, 0x70
    v_and_or_b32 v63, v5, s92, v63
    v_mov_b32 v52, s24
    v_mov_b32 v53, s24
    v_mov_b32 v54, s24
    v_mov_b32 v55, s24
    s_cmp_eq_u32 s28, 3
    s_cselect_b64 s[82:83], 1, 0
    s_mov_b32 s7, 0
    s_barrier
    ds_read_b64_tr_b16 v[64:65], v32 offset:0
    ds_read_b64_tr_b16 v[68:69], v33 offset:0
    ds_read_b64_tr_b16 v[72:73], v34 offset:0
    ds_read_b64_tr_b16 v[76:77], v35 offset:0
    ds_read_b64_tr_b16 v[80:81], v36 offset:0
    ds_read_b64_tr_b16 v[84:85], v37 offset:0
    ds_read_b64_tr_b16 v[88:89], v38 offset:0
    ds_read_b64_tr_b16 v[92:93], v39 offset:0
    ds_read_b64_tr_b16 v[96:97], v32 offset:32768
    ds_read_b64_tr_b16 v[100:101], v33 offset:32768
    ds_read_b64_tr_b16 v[104:105], v34 offset:32768
    ds_read_b64_tr_b16 v[108:109], v35 offset:32768
    ds_read_b64_tr_b16 v[112:113], v36 offset:32768
    ds_read_b64_tr_b16 v[116:117], v37 offset:32768
    ds_read_b64_tr_b16 v[120:121], v38 offset:32768
    ds_read_b64_tr_b16 v[124:125], v39 offset:32768
    ds_read_b64_tr_b16 v[128:129], v40 offset:0
    ds_read_b64_tr_b16 v[132:133], v41 offset:0
    ds_read_b64_tr_b16 v[136:137], v42 offset:0
    ds_read_b64_tr_b16 v[140:141], v43 offset:0
    ds_read_b64_tr_b16 v[144:145], v44 offset:0
    ds_read_b64_tr_b16 v[148:149], v45 offset:0
    ds_read_b64_tr_b16 v[152:153], v46 offset:0
    ds_read_b64_tr_b16 v[156:157], v47 offset:0
    ds_read_b64_tr_b16 v[160:161], v40 offset:32768
    ds_read_b64_tr_b16 v[164:165], v41 offset:32768
    ds_read_b64_tr_b16 v[168:169], v42 offset:32768
    ds_read_b64_tr_b16 v[172:173], v43 offset:32768
    ds_read_b64_tr_b16 v[176:177], v44 offset:32768
    ds_read_b64_tr_b16 v[180:181], v45 offset:32768
    ds_read_b64_tr_b16 v[184:185], v46 offset:32768
    ds_read_b64_tr_b16 v[188:189], v47 offset:32768
    s_barrier
    buffer_load_dwordx4 v[224:227], v5, s[12:15], s97 offen offset:0 sc1
    buffer_load_dwordx4 v[228:231], v5, s[12:15], s97 offen offset:1024 sc1
    buffer_load_dwordx4 v[232:235], v5, s[12:15], s97 offen offset:2048 sc1
    buffer_load_dwordx4 v[236:239], v5, s[12:15], s97 offen offset:3072 sc1
    buffer_load_dwordx4 v[240:243], v5, s[12:15], s98 offen offset:0 sc1
    buffer_load_dwordx4 v[244:247], v5, s[12:15], s98 offen offset:1024 sc1
    buffer_load_dwordx4 v[248:251], v5, s[12:15], s98 offen offset:2048 sc1
    buffer_load_dwordx4 v[252:255], v5, s[12:15], s98 offen offset:3072 sc1
    s_barrier
    ds_read_b64_tr_b16 v[66:67], v32 offset:16384
    ds_read_b64_tr_b16 v[70:71], v33 offset:16384
    ds_read_b64_tr_b16 v[74:75], v34 offset:16384
    ds_read_b64_tr_b16 v[78:79], v35 offset:16384
    ds_read_b64_tr_b16 v[82:83], v36 offset:16384
    ds_read_b64_tr_b16 v[86:87], v37 offset:16384
    ds_read_b64_tr_b16 v[90:91], v38 offset:16384
    ds_read_b64_tr_b16 v[94:95], v39 offset:16384
    ds_read_b64_tr_b16 v[98:99], v32 offset:49152
    ds_read_b64_tr_b16 v[102:103], v33 offset:49152
    ds_read_b64_tr_b16 v[106:107], v34 offset:49152
    ds_read_b64_tr_b16 v[110:111], v35 offset:49152
    ds_read_b64_tr_b16 v[114:115], v36 offset:49152
    ds_read_b64_tr_b16 v[118:119], v37 offset:49152
    ds_read_b64_tr_b16 v[122:123], v38 offset:49152
    ds_read_b64_tr_b16 v[126:127], v39 offset:49152
    ds_read_b64_tr_b16 v[130:131], v40 offset:16384
    ds_read_b64_tr_b16 v[134:135], v41 offset:16384
    ds_read_b64_tr_b16 v[138:139], v42 offset:16384
    ds_read_b64_tr_b16 v[142:143], v43 offset:16384
    ds_read_b64_tr_b16 v[146:147], v44 offset:16384
    ds_read_b64_tr_b16 v[150:151], v45 offset:16384
    ds_read_b64_tr_b16 v[154:155], v46 offset:16384
    ds_read_b64_tr_b16 v[158:159], v47 offset:16384
    ds_read_b64_tr_b16 v[162:163], v40 offset:49152
    ds_read_b64_tr_b16 v[166:167], v41 offset:49152
    ds_read_b64_tr_b16 v[170:171], v42 offset:49152
    ds_read_b64_tr_b16 v[174:175], v43 offset:49152
    ds_read_b64_tr_b16 v[178:179], v44 offset:49152
    ds_read_b64_tr_b16 v[182:183], v45 offset:49152
    ds_read_b64_tr_b16 v[186:187], v46 offset:49152
    ds_read_b64_tr_b16 v[190:191], v47 offset:49152
L_qc:
    s_waitcnt vmcnt(7)
    v_xor_b32 v224, v48, v224
    v_xor_b32 v225, v49, v225
    v_xor_b32 v226, v50, v226
    v_xor_b32 v227, v51, v227
    v_or_b32 v8, v224, v225
    v_or3_b32 v8, v8, v226, v227
    ds_write_b128 v192, v[224:227] offset:0
    s_waitcnt vmcnt(6)
    v_xor_b32 v228, v48, v228
    v_xor_b32 v229, v49, v229
    v_xor_b32 v230, v50, v230
    v_xor_b32 v231, v51, v231
    v_or3_b32 v8, v8, v228, v229
    v_or3_b32 v8, v8, v230, v231
    ds_write_b128 v193, v[228:231] offset:1024
    s_waitcnt vmcnt(5)
    v_xor_b32 v232, v48, v232
    v_xor_b32 v233, v49, v233
    v_xor_b32 v234, v50, v234
    v_xor_b32 v235, v51, v235
    v_or3_b32 v8, v8, v232, v233
    v_or3_b32 v8, v8, v234, v235
    ds_write_b128 v194, v[232:235] offset:2048
    s_waitcnt vmcnt(4)
    v_xor_b32 v236, v48, v236
    v_xor_b32 v237, v49, v237
    v_xor_b32 v238, v50, v238
    v_xor_b32 v239, v51, v239
    v_or3_b32 v8, v8, v236, v237
    v_or3_b32 v8, v8, v238, v239
    ds_write_b128 v195, v[236:239] offset:3072
    s_waitcnt vmcnt(3)
    v_xor_b32 v240, v48, v240
    v_xor_b32 v241, v49, v241
    v_xor_b32 v242, v50, v242
    v_xor_b32 v243, v51, v243
    v_or3_b32 v8, v8, v240, v241
    v_or3_b32 v8, v8, v242, v243
    ds_write_b128 v196, v[240:243] offset:4096
    s_waitcnt vmcnt(2)
    v_xor_b32 v244, v48, v244
    v_xor_b32 v245, v49, v245
    v_xor_b32 v246, v50, v246
    v_xor_b32 v247, v51, v247
    v_or3_b32 v8, v8, v244, v245
    v_or3_b32 v8, v8, v246, v247
    ds_write_b128 v197, v[244:247] offset:5120
    s_waitcnt vmcnt(1)
    v_xor_b32 v248, v48, v248
    v_xor_b32 v249, v49, v249
    v_xor_b32 v250, v50, v250
    v_xor_b32 v251, v51, v251
    v_or3_b32 v8, v8, v248, v249
    v_or3_b32 v8, v8, v250, v251
    ds_write_b128 v198, v[248:251] offset:6144
    s_waitcnt vmcnt(0)
    v_xor_b32 v252, v48, v252
    v_xor_b32 v253, v49, v253
    v_xor_b32 v254, v50, v254
    v_xor_b32 v255, v51, v255
    v_or3_b32 v8, v8, v252, v253
    v_or3_b32 v8, v8, v254, v255
    ds_write_b128 v199, v[252:255] offset:7168
    s_waitcnt lgkmcnt(0)
    v_and_b32 v8, 0x10001, v8
    v_cmp_ne_u32 vcc, 0, v8
    s_add_u32 s7, s7, 1
    s_cmp_lt_u32 s7, 20000
    s_cselect_b64 vcc, vcc, 0
    s_cbranch_vccnz L_qr
L_qok:
    s_barrier
    s_mov_b64 exec, s[82:83]
    buffer_atomic_add v62, v63, s[12:15], s80 offen sc0 sc1
    s_mov_b64 exec, -1
    s_barrier
    s_barrier
    ds_read_b128 v[192:195], v15 offset:0
    ds_read_b128 v[196:199], v15 offset:2048
    ds_read_b128 v[200:203], v15 offset:4096
    ds_read_b128 v[204:207], v15 offset:6144
    s_waitcnt lgkmcnt(3)
    v_mfma_f32_16x16x32_bf16 v[224:227], v[192:195], v[64:67], 0
    v_mfma_f32_16x16x32_bf16 v[228:231], v[192:195], v[68:71], 0
    v_mfma_f32_16x16x32_bf16 v[232:235], v[192:195], v[72:75], 0
    v_mfma_f32_16x16x32_bf16 v[236:239], v[192:195], v[76:79], 0
    v_mfma_f32_16x16x32_bf16 v[240:243], v[192:195], v[80:83], 0
    v_mfma_f32_16x16x32_bf16 v[244:247], v[192:195], v[84:87], 0
    v_mfma_f32_16x16x32_bf16 v[248:251], v[192:195], v[88:91], 0
    v_mfma_f32_16x16x32_bf16 v[252:255], v[192:195], v[92:95], 0
    s_waitcnt lgkmcnt(2)
    v_mfma_f32_16x16x32_bf16 v[224:227], v[196:199], v[96:99], v[224:227]
    v_mfma_f32_16x16x32_bf16 v[228:231], v[196:199], v[100:103], v[228:231]
    s_barrier
    v_mfma_f32_16x16x32_bf16 v[232:235], v[196:199], v[104:107], v[232:235]
    v_mfma_f32_16x16x32_bf16 v[236:239], v[196:199], v[108:111], v[236:239]
    v_mfma_f32_16x16x32_bf16 v[240:243], v[196:199], v[112:115], v[240:243]
    v_mfma_f32_16x16x32_bf16 v[244:247], v[196:199], v[116:119], v[244:247]
    v_mfma_f32_16x16x32_bf16 v[248:251], v[196:199], v[120:123], v[248:251]
    v_mfma_f32_16x16x32_bf16 v[252:255], v[196:199], v[124:127], v[252:255]
    s_waitcnt lgkmcnt(1)
    v_mfma_f32_16x16x32_bf16 v[224:227], v[200:203], v[128:131], v[224:227]
    v_mfma_f32_16x16x32_bf16 v[228:231], v[200:203], v[132:135], v[228:231]
    v_mfma_f32_16x16x32_bf16 v[232:235], v[200:203], v[136:139], v[232:235]
    v_mfma_f32_16x16x32_bf16 v[236:239], v[200:203], v[140:143], v[236:239]
    v_mfma_f32_16x16x32_bf16 v[240:243], v[200:203], v[144:147], v[240:243]
    v_mfma_f32_16x16x32_bf16 v[244:247], v[200:203], v[148:151], v[244:247]
    v_mfma_f32_16x16x32_bf16 v[248:251], v[200:203], v[152:155], v[248:251]
    v_mfma_f32_16x16x32_bf16 v[252:255], v[200:203], v[156:159], v[252:255]
    s_waitcnt lgkmcnt(0)
    v_mfma_f32_16x16x32_bf16 v[224:227], v[204:207], v[160:163], v[224:227]
    v_mfma_f32_16x16x32_bf16 v[228:231], v[204:207], v[164:167], v[228:231]
    v_mfma_f32_16x16x32_bf16 v[232:235], v[204:207], v[168:171], v[232:235]
    s_waitcnt vmcnt(0)
    v_readfirstlane_b32 s92, v62
    v_mfma_f32_16x16x32_bf16 v[236:239], v[204:207], v[172:175], v[236:239]
    s_nop 0
    s_cmp_eq_u32 s92, 15
    s_cselect_b64 s[82:83], -1, 0
    v_mfma_f32_16x16x32_bf16 v[240:243], v[204:207], v[176:179], v[240:243]
    v_mfma_f32_16x16x32_bf16 v[244:247], v[204:207], v[180:183], v[244:247]
    s_barrier
    ds_read_b128 v[16:19], v15 offset:1024
    ds_read_b128 v[20:23], v15 offset:3072
    ds_read_b128 v[24:27], v15 offset:5120
    ds_read_b128 v[28:31], v15 offset:7168
    v_mfma_f32_16x16x32_bf16 v[248:251], v[204:207], v[184:187], v[248:251]
    v_mfma_f32_16x16x32_bf16 v[252:255], v[204:207], v[188:191], v[252:255]
    s_waitcnt lgkmcnt(3)
    v_mfma_f32_16x16x32_bf16 v[192:195], v[16:19], v[64:67], 0
    v_mfma_f32_16x16x32_bf16 v[196:199], v[16:19], v[68:71], 0
    v_cvt_pk_bf16_f32 v32, v224, v228
    v_cvt_pk_bf16_f32 v33, v232, v236
    v_mfma_f32_16x16x32_bf16 v[200:203], v[16:19], v[72:75], 0
    v_cvt_pk_bf16_f32 v34, v240, v244
    s_nop 0
    v_cvt_pk_bf16_f32 v35, v248, v252
    v_mfma_f32_16x16x32_bf16 v[204:207], v[16:19], v[76:79], 0
    v_and_or_b32 v32, v32, s26, v48
    v_and_or_b32 v33, v33, s26, v49
    v_mfma_f32_16x16x32_bf16 v[208:211], v[16:19], v[80:83], 0
    v_and_or_b32 v34, v34, s26, v50
    v_and_or_b32 v35, v35, s26, v51
    buffer_store_dwordx4 v[32:35], v9, s[12:15], s64 offen sc1
    v_mfma_f32_16x16x32_bf16 v[212:215], v[16:19], v[84:87], 0
    v_cvt_pk_bf16_f32 v36, v225, v229
    v_cvt_pk_bf16_f32 v37, v233, v237
    v_mfma_f32_16x16x32_bf16 v[216:219], v[16:19], v[88:91], 0
    v_cvt_pk_bf16_f32 v38, v241, v245
    v_cvt_pk_bf16_f32 v39, v249, v253
    v_mfma_f32_16x16x32_bf16 v[220:223], v[16:19], v[92:95], 0
    v_and_or_b32 v36, v36, s26, v48
    v_and_or_b32 v37, v37, s26, v49
    s_waitcnt lgkmcnt(2)
    v_mfma_f32_16x16x32_bf16 v[192:195], v[20:23], v[96:99], v[192:195]
    v_and_or_b32 v38, v38, s26, v50
    v_and_or_b32 v39, v39, s26, v51
    buffer_store_dwordx4 v[36:39], v9, s[12:15], s65 offen sc1
    v_mfma_f32_16x16x32_bf16 v[196:199], v[20:23], v[100:103], v[196:199]
    v_cvt_pk_bf16_f32 v40, v226, v230
    v_cvt_pk_bf16_f32 v41, v234, v238
    v_mfma_f32_16x16x32_bf16 v[200:203], v[20:23], v[104:107], v[200:203]
    v_cvt_pk_bf16_f32 v42, v242, v246
    v_cvt_pk_bf16_f32 v43, v250, v254
    v_mfma_f32_16x16x32_bf16 v[204:207], v[20:23], v[108:111], v[204:207]
    v_and_or_b32 v40, v40, s26, v48
    v_and_or_b32 v41, v41, s26, v49
    v_mfma_f32_16x16x32_bf16 v[208:211], v[20:23], v[112:115], v[208:211]
    v_and_or_b32 v42, v42, s26, v50
    v_and_or_b32 v43, v43, s26, v51
    buffer_store_dwordx4 v[40:43], v9, s[12:15], s66 offen sc1
    v_mfma_f32_16x16x32_bf16 v[212:215], v[20:23], v[116:119], v[212:215]
    v_cvt_pk_bf16_f32 v44, v227, v231
    v_cvt_pk_bf16_f32 v45, v235, v239
    v_mfma_f32_16x16x32_bf16 v[216:219], v[20:23], v[120:123], v[216:219]
    v_cvt_pk_bf16_f32 v46, v243, v247
    v_cvt_pk_bf16_f32 v47, v251, v255
    v_mfma_f32_16x16x32_bf16 v[220:223], v[20:23], v[124:127], v[220:223]
    v_and_or_b32 v44, v44, s26, v48
    v_and_or_b32 v45, v45, s26, v49
    s_waitcnt lgkmcnt(1)
    v_mfma_f32_16x16x32_bf16 v[192:195], v[24:27], v[128:131], v[192:195]
    v_and_or_b32 v46, v46, s26, v50
    v_and_or_b32 v47, v47, s26, v51
    buffer_store_dwordx4 v[44:47], v9, s[12:15], s67 offen sc1
    v_mfma_f32_16x16x32_bf16 v[196:199], v[24:27], v[132:135], v[196:199]
    v_mfma_f32_16x16x32_bf16 v[200:203], v[24:27], v[136:139], v[200:203]
    v_mfma_f32_16x16x32_bf16 v[204:207], v[24:27], v[140:143], v[204:207]
    v_mfma_f32_16x16x32_bf16 v[208:211], v[24:27], v[144:147], v[208:211]
    v_mfma_f32_16x16x32_bf16 v[212:215], v[24:27], v[148:151], v[212:215]
    v_mfma_f32_16x16x32_bf16 v[216:219], v[24:27], v[152:155], v[216:219]
    v_mfma_f32_16x16x32_bf16 v[220:223], v[24:27], v[156:159], v[220:223]
    s_waitcnt lgkmcnt(0)
    v_mfma_f32_16x16x32_bf16 v[192:195], v[28:31], v[160:163], v[192:195]
    v_mfma_f32_16x16x32_bf16 v[196:199], v[28:31], v[164:167], v[196:199]
    v_mfma_f32_16x16x32_bf16 v[200:203], v[28:31], v[168:171], v[200:203]
    v_mfma_f32_16x16x32_bf16 v[204:207], v[28:31], v[172:175], v[204:207]
    v_mfma_f32_16x16x32_bf16 v[208:211], v[28:31], v[176:179], v[208:211]
    v_mfma_f32_16x16x32_bf16 v[212:215], v[28:31], v[180:183], v[212:215]
    v_mfma_f32_16x16x32_bf16 v[216:219], v[28:31], v[184:187], v[216:219]
    v_mfma_f32_16x16x32_bf16 v[220:223], v[28:31], v[188:191], v[220:223]
    s_nop 1
    v_cvt_pk_bf16_f32 v64, v192, v196
    s_nop 0
    v_cvt_pk_bf16_f32 v65, v200, v204
    s_nop 0
    v_cvt_pk_bf16_f32 v66, v208, v212
    s_nop 0
    v_cvt_pk_bf16_f32 v67, v216, v220
    v_and_or_b32 v64, v64, s26, v48
    v_and_or_b32 v65, v65, s26, v49
    v_and_or_b32 v66, v66, s26, v50
    v_and_or_b32 v67, v67, s26, v51
    buffer_store_dwordx4 v[64:67], v9, s[12:15], s68 offen sc1
    v_cvt_pk_bf16_f32 v68, v193, v197
    v_cvt_pk_bf16_f32 v69, v201, v205
    v_cvt_pk_bf16_f32 v70, v209, v213
    v_cvt_pk_bf16_f32 v71, v217, v221
    v_and_or_b32 v68, v68, s26, v48
    v_and_or_b32 v69, v69, s26, v49
    v_and_or_b32 v70, v70, s26, v50
    v_and_or_b32 v71, v71, s26, v51
    buffer_store_dwordx4 v[68:71], v9, s[12:15], s69 offen sc1
    v_cvt_pk_bf16_f32 v72, v194, v198
    v_cvt_pk_bf16_f32 v73, v202, v206
    v_cvt_pk_bf16_f32 v74, v210, v214
    v_cvt_pk_bf16_f32 v75, v218, v222
    v_and_or_b32 v72, v72, s26, v48
    v_and_or_b32 v73, v73, s26, v49
    v_and_or_b32 v74, v74, s26, v50
    v_and_or_b32 v75, v75, s26, v51
    buffer_store_dwordx4 v[72:75], v9, s[12:15], s70 offen sc1
    s_mov_b64 exec, s[82:83]
    buffer_store_dwordx4 v[52:55], v63, s[12:15], s81 offen sc1
    s_mov_b64 exec, -1
    v_cvt_pk_bf16_f32 v76, v195, v199
    v_cvt_pk_bf16_f32 v77, v203, v207
    v_cvt_pk_bf16_f32 v78, v211, v215
    v_cvt_pk_bf16_f32 v79, v219, v223
    v_and_or_b32 v76, v76, s26, v48
    v_and_or_b32 v77, v77, s26, v49
    v_and_or_b32 v78, v78, s26, v50
    v_and_or_b32 v79, v79, s26, v51
    buffer_store_dwordx4 v[76:79], v9, s[12:15], s71 offen sc1
    s_waitcnt vmcnt(16)
    s_barrier
    s_and_b32 s92, s2, 7
    s_lshl_b32 s92, s92, 5

    v_and_b32 v22, 7, v0
    v_lshl_add_u32 v22, v22, 2, s92
    global_load_dword v22, v22, s[88:89] sc1
    s_mov_b32 s30, 0x05040100
    s_mov_b32 s31, 0x07060302
    s_mov_b32 s16, s84
    s_mov_b32 s17, s85
    s_mov_b32 s18, 0x400000
    s_mov_b32 s19, 0x20000
    s_and_b32 s92, s5, 3
    s_andn2_b32 s5, s5, 3
    s_or_b32 s5, s5, s6
    s_xor_b32 s6, s92, 3
    s_lshl_b32 s25, s5, 17
    s_lshl_b32 s93, s28, 15
    s_add_u32 s25, s25, s93
    s_lshl_b32 s93, s6, 8
    s_add_u32 s25, s25, s93
    v_lshlrev_b32 v1, 4, v61
    v_lshl_add_u32 v1, v60, 11, v1
    s_lshl_b32 s99, s5, 13
    s_lshl_b32 s93, s28, 11
    s_add_u32 s99, s99, s93
    s_add_u32 s99, s99, 0x100000
    s_lshl_b32 s92, s28, 11
    s_add_u32 s92, s92, 0x26000
    v_add_u32 v3, s92, v5
    v_mov_b32 v20, 1.0
    s_mov_b32 s94, 4
    s_mov_b32 s7, 0
    s_mov_b32 s27, s99
    s_waitcnt vmcnt(0)
    s_getreg_b32 s95, hwreg(HW_REG_XCC_ID, 0, 4)
    s_add_u32 s95, s95, 1
    s_mul_i32 s95, s95, 0x01010101
    v_cmp_ne_u32 vcc, s95, v22
    s_nop 1
    s_cmp_eq_u64 vcc, 0
    s_cselect_b32 s95, 0, 0x200000
    s_barrier
    buffer_load_dwordx4 v[32:35], v1, s[16:19], s25 offen offset:0 nt
    buffer_load_dwordx4 v[36:39], v1, s[16:19], s25 offen offset:1024 nt
    s_add_u32 s25, s25, 0x2000
    buffer_load_dwordx4 v[40:43], v1, s[16:19], s25 offen offset:0 nt
    buffer_load_dwordx4 v[44:47], v1, s[16:19], s25 offen offset:1024 nt
    s_add_u32 s25, s25, 0x2000
    buffer_load_dwordx4 v[48:51], v1, s[16:19], s25 offen offset:0 nt
    buffer_load_dwordx4 v[52:55], v1, s[16:19], s25 offen offset:1024 nt
    s_add_u32 s25, s25, 0x2000
    buffer_load_dwordx4 v[56:59], v1, s[16:19], s25 offen offset:0 nt
    buffer_load_dwordx4 v[60:63], v1, s[16:19], s25 offen offset:1024 nt
    s_barrier
    s_waitcnt vmcnt(6)
    v_perm_b32 v64, v36, v32, s30
    v_perm_b32 v68, v36, v32, s31
    v_perm_b32 v72, v37, v33, s30
    v_perm_b32 v76, v37, v33, s31
    v_perm_b32 v80, v38, v34, s30
    v_perm_b32 v84, v38, v34, s31
    v_perm_b32 v88, v39, v35, s30
    v_perm_b32 v92, v39, v35, s31
    s_waitcnt vmcnt(4)
    v_perm_b32 v65, v44, v40, s30
    v_perm_b32 v69, v44, v40, s31
    v_perm_b32 v73, v45, v41, s30
    v_perm_b32 v77, v45, v41, s31
    v_perm_b32 v81, v46, v42, s30
    v_perm_b32 v85, v46, v42, s31
    v_perm_b32 v89, v47, v43, s30
    v_perm_b32 v93, v47, v43, s31
    s_barrier
    buffer_load_dwordx4 v[96:99], v5, s[12:15], s27 offen sc1
    buffer_load_dwordx4 v[100:103], v5, s[12:15], s27 offen offset:1024 sc1
    s_waitcnt vmcnt(4)
    v_perm_b32 v66, v52, v48, s30
    v_perm_b32 v70, v52, v48, s31
    v_perm_b32 v74, v53, v49, s30
    v_perm_b32 v78, v53, v49, s31
    v_perm_b32 v82, v54, v50, s30
    v_perm_b32 v86, v54, v50, s31
    v_perm_b32 v90, v55, v51, s30
    v_perm_b32 v94, v55, v51, s31
    s_waitcnt vmcnt(2)
    v_perm_b32 v67, v60, v56, s30
    v_perm_b32 v71, v60, v56, s31
    v_perm_b32 v75, v61, v57, s30
    v_perm_b32 v79, v61, v57, s31
    v_perm_b32 v83, v62, v58, s30
    v_perm_b32 v87, v62, v58, s31
    v_perm_b32 v91, v63, v59, s30
    v_perm_b32 v95, v63, v59, s31
L_Bc:
    s_waitcnt vmcnt(1)
    v_xor_b32 v96, s8, v96
    v_xor_b32 v97, s9, v97
    v_xor_b32 v98, s10, v98
    v_xor_b32 v99, s11, v99
    v_or_b32 v8, v96, v97
    v_or3_b32 v8, v8, v98, v99
    s_waitcnt vmcnt(0)
    v_xor_b32 v100, s8, v100
    v_xor_b32 v101, s9, v101
    v_xor_b32 v102, s10, v102
    v_xor_b32 v103, s11, v103
    v_or3_b32 v8, v8, v100, v101
    v_or3_b32 v8, v8, v102, v103
    v_cmp_ne_u32_sdwa vcc, v8, 0 src0_sel:BYTE_0 src1_sel:DWORD
    v_permlane32_swap_b32 v96, v100
    v_permlane32_swap_b32 v97, v101
    s_cbranch_vccnz L_Bp
L_Bd:
    v_permlane32_swap_b32 v98, v102
    v_permlane32_swap_b32 v99, v103
    v_pk_add_f32 v[96:97], v[96:97], v[100:101]
    v_pk_add_f32 v[98:99], v[98:99], v[102:103]
    s_nop 1
    v_permlane16_swap_b32 v96, v98
    v_permlane16_swap_b32 v97, v99
    v_pk_add_f32 v[96:97], v[96:97], v[98:99]
    v_cvt_pk_bf16_f32 v96, v96, v97
    s_nop 1
    v_mov_b32_dpp v24, v96 quad_perm:[0,0,0,0] row_mask:0xf bank_mask:0xf
    v_mov_b32_dpp v25, v96 quad_perm:[1,1,1,1] row_mask:0xf bank_mask:0xf
    v_mov_b32_dpp v26, v96 quad_perm:[2,2,2,2] row_mask:0xf bank_mask:0xf
    v_mov_b32_dpp v27, v96 quad_perm:[3,3,3,3] row_mask:0xf bank_mask:0xf
    s_nop 1
    v_mfma_f32_16x16x32_bf16 v[160:163], v[24:27], v[64:67], 0
    v_mfma_f32_16x16x32_bf16 v[164:167], v[24:27], v[68:71], 0
    v_mfma_f32_16x16x32_bf16 v[168:171], v[24:27], v[72:75], 0
    v_mfma_f32_16x16x32_bf16 v[172:175], v[24:27], v[76:79], 0
    v_mfma_f32_16x16x32_bf16 v[176:179], v[24:27], v[80:83], 0
    s_nop 3
    v_mov_b32 v96, v160
    v_mfma_f32_16x16x32_bf16 v[180:183], v[24:27], v[84:87], 0
    v_mov_b32 v97, v164
    v_mfma_f32_16x16x32_bf16 v[184:187], v[24:27], v[88:91], 0
    v_mov_b32 v98, v168
    v_mfma_f32_16x16x32_bf16 v[188:191], v[24:27], v[92:95], 0
    v_mov_b32 v99, v172
    ds_write_b128 v3, v[96:99]
    v_mov_b32 v100, v176
    s_nop 0
    v_mov_b32 v101, v180
    s_nop 0
    v_mov_b32 v102, v184
    s_nop 0
    v_mov_b32 v103, v188
    ds_write_b128 v3, v[100:103] offset:1024
    s_waitcnt lgkmcnt(0)
    s_barrier
    s_endpgm
L_Bp:
    s_add_u32 s7, s7, 1
    s_cmp_lt_u32 s7, 20000
    s_cbranch_scc0 L_Bd
    s_and_b32 s92, s7, 7
    s_cmp_eq_u32 s92, 7
    s_cselect_b32 s92, s95, 0
    s_add_u32 s27, s99, s92
    buffer_load_dwordx4 v[96:99], v5, s[12:15], s27 offen sc1
    buffer_load_dwordx4 v[100:103], v5, s[12:15], s27 offen offset:1024 sc1
    s_branch L_Bc
L_zr:
    buffer_load_dword v21, v22, s[12:15], s100 offen sc1
    s_waitcnt vmcnt(0)
    v_xor_b32 v21, s24, v21
    v_cmp_ne_u32 vcc, 0, v21
    s_add_u32 s7, s7, 1
    s_cmp_lt_u32 s7, 20000
    s_cselect_b64 vcc, vcc, 0
    s_cbranch_vccnz L_zr
    s_mov_b32 s7, 0
    s_branch L_zk
L_U2w:
    s_waitcnt lgkmcnt(0)
L_U2g:
    s_mov_b64 exec, s[96:97]
    buffer_load_dwordx4 v[12:15], v11, s[12:15], s100 offen sc1
    buffer_load_dwordx4 v[16:19], v11, s[12:15], s100 offen offset:64 sc1
    s_mov_b64 exec, -1
    s_waitcnt vmcnt(0)
    v_mov_b32 v21, 0
    s_mov_b64 exec, s[96:97]
    v_xor_b32 v21, s24, v14
    v_bitop3_b32 v21, v15, s24, v21 bitop3:0xbe
    v_bitop3_b32 v21, v18, s24, v21 bitop3:0xbe
    v_bitop3_b32 v21, v19, s24, v21 bitop3:0xbe
    s_mov_b64 exec, -1
    v_cmp_ne_u32 vcc, 0, v21
    s_add_u32 s7, s7, 1
    s_cmp_lt_u32 s7, 20000
    s_cselect_b64 vcc, vcc, 0
    s_cbranch_vccnz L_U2g
    v_max_f32 v8, v12, v16
    s_nop 1
    v_max_f32_dpp v8, v8, v8 quad_perm:[1,0,3,2] row_mask:0xf bank_mask:0xf
    s_nop 1
    v_max_f32_dpp v8, v8, v8 quad_perm:[2,3,0,1] row_mask:0xf bank_mask:0xf
    v_mov_b32 v22, v8
    s_nop 1
    v_permlane32_swap_b32 v8, v22
    v_max_f32 v8, v8, v22
    v_mov_b32 v22, v8
    s_nop 1
    v_permlane16_swap_b32 v8, v22
    v_max_f32 v8, v8, v22
    v_sub_f32 v12, v12, v8
    v_sub_f32 v16, v16, v8
    v_exp_f32 v12, v12
    v_exp_f32 v16, v16
    v_mul_f32 v8, v12, v13
    v_fmac_f32 v8, v16, v17
    s_nop 1
    v_add_f32_dpp v8, v8, v8 quad_perm:[1,0,3,2] row_mask:0xf bank_mask:0xf
    s_nop 1
    v_add_f32_dpp v8, v8, v8 quad_perm:[2,3,0,1] row_mask:0xf bank_mask:0xf
    v_mov_b32 v22, v8
    s_nop 1
    v_permlane32_swap_b32 v8, v22
    v_add_f32 v8, v8, v22
    v_mov_b32 v22, v8
    s_nop 1
    v_permlane16_swap_b32 v8, v22
    v_add_f32 v8, v8, v22
    v_rcp_f32 v8, v8
    s_nop 0
    v_mul_f32 v12, v12, v8
    v_mul_f32 v16, v16, v8
    v_cvt_pk_bf16_f32 v12, v12, v16
    s_nop 1
    v_mov_b32_dpp v16, v12 quad_perm:[0,0,0,0] row_mask:0xf bank_mask:0xf
    v_mov_b32_dpp v17, v12 quad_perm:[1,1,1,1] row_mask:0xf bank_mask:0xf
    v_mov_b32_dpp v18, v12 quad_perm:[2,2,2,2] row_mask:0xf bank_mask:0xf
    v_mov_b32_dpp v19, v12 quad_perm:[3,3,3,3] row_mask:0xf bank_mask:0xf
    v_or3_b32 v8, v96, v97, v98
    v_or_b32 v8, v8, v99
    v_and_b32 v8, 0x10001, v8
    v_cmp_ne_u32 vcc, 0, v8
    s_nop 1
    s_wqm_b64 s[64:65], vcc
    v_or3_b32 v8, v100, v101, v102
    v_or_b32 v8, v8, v103
    v_and_b32 v8, 0x10001, v8
    v_cmp_ne_u32 vcc, 0, v8
    s_nop 1
    s_wqm_b64 s[66:67], vcc
    v_or3_b32 v8, v104, v105, v106
    v_or_b32 v8, v8, v107
    v_and_b32 v8, 0x10001, v8
    v_cmp_ne_u32 vcc, 0, v8
    s_nop 1
    s_wqm_b64 s[68:69], vcc
    v_or3_b32 v8, v108, v109, v110
    v_or_b32 v8, v8, v111
    v_and_b32 v8, 0x10001, v8
    v_cmp_ne_u32 vcc, 0, v8
    s_nop 1
    s_wqm_b64 s[70:71], vcc
    v_or3_b32 v8, v112, v113, v114
    v_or_b32 v8, v8, v115
    v_and_b32 v8, 0x10001, v8
    v_cmp_ne_u32 vcc, 0, v8
    s_nop 1
    s_wqm_b64 s[72:73], vcc
    v_or3_b32 v8, v116, v117, v118
    v_or_b32 v8, v8, v119
    v_and_b32 v8, 0x10001, v8
    v_cmp_ne_u32 vcc, 0, v8
    s_nop 1
    s_wqm_b64 s[74:75], vcc
    v_or3_b32 v8, v120, v121, v122
    v_or_b32 v8, v8, v123
    v_and_b32 v8, 0x10001, v8
    v_cmp_ne_u32 vcc, 0, v8
    s_nop 1
    s_wqm_b64 s[76:77], vcc
    v_or3_b32 v8, v124, v125, v126
    v_or_b32 v8, v8, v127
    v_and_b32 v8, 0x10001, v8
    v_cmp_ne_u32 vcc, 0, v8
    s_nop 1
    s_wqm_b64 s[78:79], vcc
Lsr_13:
    s_mov_b64 exec, s[64:65]
    buffer_load_dwordx4 v[96:99], v9, s[12:15], s101 offen offset:0 sc1
    s_mov_b64 exec, s[66:67]
    buffer_load_dwordx4 v[100:103], v9, s[12:15], s101 offen offset:1024 sc1
    s_mov_b64 exec, s[68:69]
    buffer_load_dwordx4 v[104:107], v9, s[12:15], s101 offen offset:2048 sc1
    s_mov_b64 exec, s[70:71]
    buffer_load_dwordx4 v[108:111], v9, s[12:15], s101 offen offset:3072 sc1
    s_mov_b64 exec, s[72:73]
    buffer_load_dwordx4 v[112:115], v9, s[12:15], s81 offen offset:0 sc1
    s_mov_b64 exec, s[74:75]
    buffer_load_dwordx4 v[116:119], v9, s[12:15], s81 offen offset:1024 sc1
    s_mov_b64 exec, s[76:77]
    buffer_load_dwordx4 v[120:123], v9, s[12:15], s81 offen offset:2048 sc1
    s_mov_b64 exec, s[78:79]
    buffer_load_dwordx4 v[124:127], v9, s[12:15], s81 offen offset:3072 sc1
    s_mov_b64 s[92:93], 0
    s_waitcnt vmcnt(0)
    s_mov_b64 exec, s[64:65]
    s_cbranch_execz Lsk_14
    v_xor_b32 v96, v28, v96
    v_xor_b32 v97, v29, v97
    v_xor_b32 v98, v30, v98
    v_xor_b32 v99, v31, v99
    v_or3_b32 v8, v96, v97, v98
    v_or_b32 v8, v8, v99
    v_and_b32 v8, 0x10001, v8
    v_cmp_ne_u32 vcc, 0, v8
    s_nop 1
    s_wqm_b64 s[64:65], vcc
    s_or_b64 s[92:93], s[92:93], s[64:65]
Lsk_14:
    s_mov_b64 exec, s[66:67]
    s_cbranch_execz Lsk_15
    v_xor_b32 v100, v28, v100
    v_xor_b32 v101, v29, v101
    v_xor_b32 v102, v30, v102
    v_xor_b32 v103, v31, v103
    v_or3_b32 v8, v100, v101, v102
    v_or_b32 v8, v8, v103
    v_and_b32 v8, 0x10001, v8
    v_cmp_ne_u32 vcc, 0, v8
    s_nop 1
    s_wqm_b64 s[66:67], vcc
    s_or_b64 s[92:93], s[92:93], s[66:67]
Lsk_15:
    s_mov_b64 exec, s[68:69]
    s_cbranch_execz Lsk_16
    v_xor_b32 v104, v28, v104
    v_xor_b32 v105, v29, v105
    v_xor_b32 v106, v30, v106
    v_xor_b32 v107, v31, v107
    v_or3_b32 v8, v104, v105, v106
    v_or_b32 v8, v8, v107
    v_and_b32 v8, 0x10001, v8
    v_cmp_ne_u32 vcc, 0, v8
    s_nop 1
    s_wqm_b64 s[68:69], vcc
    s_or_b64 s[92:93], s[92:93], s[68:69]
Lsk_16:
    s_mov_b64 exec, s[70:71]
    s_cbranch_execz Lsk_17
    v_xor_b32 v108, v28, v108
    v_xor_b32 v109, v29, v109
    v_xor_b32 v110, v30, v110
    v_xor_b32 v111, v31, v111
    v_or3_b32 v8, v108, v109, v110
    v_or_b32 v8, v8, v111
    v_and_b32 v8, 0x10001, v8
    v_cmp_ne_u32 vcc, 0, v8
    s_nop 1
    s_wqm_b64 s[70:71], vcc
    s_or_b64 s[92:93], s[92:93], s[70:71]
Lsk_17:
    s_mov_b64 exec, s[72:73]
    s_cbranch_execz Lsk_18
    v_xor_b32 v112, v28, v112
    v_xor_b32 v113, v29, v113
    v_xor_b32 v114, v30, v114
    v_xor_b32 v115, v31, v115
    v_or3_b32 v8, v112, v113, v114
    v_or_b32 v8, v8, v115
    v_and_b32 v8, 0x10001, v8
    v_cmp_ne_u32 vcc, 0, v8
    s_nop 1
    s_wqm_b64 s[72:73], vcc
    s_or_b64 s[92:93], s[92:93], s[72:73]
Lsk_18:
    s_mov_b64 exec, s[74:75]
    s_cbranch_execz Lsk_19
    v_xor_b32 v116, v28, v116
    v_xor_b32 v117, v29, v117
    v_xor_b32 v118, v30, v118
    v_xor_b32 v119, v31, v119
    v_or3_b32 v8, v116, v117, v118
    v_or_b32 v8, v8, v119
    v_and_b32 v8, 0x10001, v8
    v_cmp_ne_u32 vcc, 0, v8
    s_nop 1
    s_wqm_b64 s[74:75], vcc
    s_or_b64 s[92:93], s[92:93], s[74:75]
Lsk_19:
    s_mov_b64 exec, s[76:77]
    s_cbranch_execz Lsk_20
    v_xor_b32 v120, v28, v120
    v_xor_b32 v121, v29, v121
    v_xor_b32 v122, v30, v122
    v_xor_b32 v123, v31, v123
    v_or3_b32 v8, v120, v121, v122
    v_or_b32 v8, v8, v123
    v_and_b32 v8, 0x10001, v8
    v_cmp_ne_u32 vcc, 0, v8
    s_nop 1
    s_wqm_b64 s[76:77], vcc
    s_or_b64 s[92:93], s[92:93], s[76:77]
Lsk_20:
    s_mov_b64 exec, s[78:79]
    s_cbranch_execz Lsk_21
    v_xor_b32 v124, v28, v124
    v_xor_b32 v125, v29, v125
    v_xor_b32 v126, v30, v126
    v_xor_b32 v127, v31, v127
    v_or3_b32 v8, v124, v125, v126
    v_or_b32 v8, v8, v127
    v_and_b32 v8, 0x10001, v8
    v_cmp_ne_u32 vcc, 0, v8
    s_nop 1
    s_wqm_b64 s[78:79], vcc
    s_or_b64 s[92:93], s[92:93], s[78:79]
Lsk_21:
    s_mov_b64 exec, -1

    s_add_u32 s7, s7, 1
    s_cmp_eq_u64 s[92:93], 0
    s_cbranch_scc1 L_or2
    s_cmp_lt_u32 s7, 20000
    s_cbranch_scc1 Lsr_13
    s_branch L_or2
L_or2:
    v_perm_b32 v64, v100, v96, s30
    v_perm_b32 v68, v100, v96, s31
    v_perm_b32 v72, v101, v97, s30
    v_perm_b32 v76, v101, v97, s31
    v_perm_b32 v80, v102, v98, s30
    v_perm_b32 v84, v102, v98, s31
    v_perm_b32 v88, v103, v99, s30
    v_perm_b32 v92, v103, v99, s31
    v_perm_b32 v65, v108, v104, s30
    v_perm_b32 v69, v108, v104, s31
    v_perm_b32 v73, v109, v105, s30
    v_perm_b32 v77, v109, v105, s31
    v_perm_b32 v81, v110, v106, s30
    v_perm_b32 v85, v110, v106, s31
    v_perm_b32 v89, v111, v107, s30
    v_perm_b32 v93, v111, v107, s31
    v_perm_b32 v66, v116, v112, s30
    v_perm_b32 v70, v116, v112, s31
    v_perm_b32 v74, v117, v113, s30
    v_perm_b32 v78, v117, v113, s31
    v_perm_b32 v82, v118, v114, s30
    v_perm_b32 v86, v118, v114, s31
    v_perm_b32 v90, v119, v115, s30
    v_perm_b32 v94, v119, v115, s31
    v_perm_b32 v67, v124, v120, s30
    v_perm_b32 v71, v124, v120, s31
    s_branch L_ook
L_qr:
    v_or3_b32 v8, v224, v225, v226
    v_or_b32 v8, v8, v227
    v_and_b32 v8, 0x10001, v8
    v_cmp_ne_u32 vcc, 0, v8
    s_nop 1
    s_wqm_b64 s[34:35], vcc
    v_or3_b32 v8, v228, v229, v230
    v_or_b32 v8, v8, v231
    v_and_b32 v8, 0x10001, v8
    v_cmp_ne_u32 vcc, 0, v8
    s_nop 1
    s_wqm_b64 s[36:37], vcc
    v_or3_b32 v8, v232, v233, v234
    v_or_b32 v8, v8, v235
    v_and_b32 v8, 0x10001, v8
    v_cmp_ne_u32 vcc, 0, v8
    s_nop 1
    s_wqm_b64 s[38:39], vcc
    v_or3_b32 v8, v236, v237, v238
    v_or_b32 v8, v8, v239
    v_and_b32 v8, 0x10001, v8
    v_cmp_ne_u32 vcc, 0, v8
    s_nop 1
    s_wqm_b64 s[40:41], vcc
    v_or3_b32 v8, v240, v241, v242
    v_or_b32 v8, v8, v243
    v_and_b32 v8, 0x10001, v8
    v_cmp_ne_u32 vcc, 0, v8
    s_nop 1
    s_wqm_b64 s[42:43], vcc
    v_or3_b32 v8, v244, v245, v246
    v_or_b32 v8, v8, v247
    v_and_b32 v8, 0x10001, v8
    v_cmp_ne_u32 vcc, 0, v8
    s_nop 1
    s_wqm_b64 s[44:45], vcc
    v_or3_b32 v8, v248, v249, v250
    v_or_b32 v8, v8, v251
    v_and_b32 v8, 0x10001, v8
    v_cmp_ne_u32 vcc, 0, v8
    s_nop 1
    s_wqm_b64 s[46:47], vcc
    v_or3_b32 v8, v252, v253, v254
    v_or_b32 v8, v8, v255
    v_and_b32 v8, 0x10001, v8
    v_cmp_ne_u32 vcc, 0, v8
    s_nop 1
    s_wqm_b64 s[48:49], vcc
Lsr_22:
    s_mov_b64 exec, s[34:35]
    buffer_load_dwordx4 v[224:227], v5, s[12:15], s97 offen offset:0 sc1
    s_mov_b64 exec, s[36:37]
    buffer_load_dwordx4 v[228:231], v5, s[12:15], s97 offen offset:1024 sc1
    s_mov_b64 exec, s[38:39]
    buffer_load_dwordx4 v[232:235], v5, s[12:15], s97 offen offset:2048 sc1
    s_mov_b64 exec, s[40:41]
    buffer_load_dwordx4 v[236:239], v5, s[12:15], s97 offen offset:3072 sc1
    s_mov_b64 exec, s[42:43]
    buffer_load_dwordx4 v[240:243], v5, s[12:15], s98 offen offset:0 sc1
    s_mov_b64 exec, s[44:45]
    buffer_load_dwordx4 v[244:247], v5, s[12:15], s98 offen offset:1024 sc1
    s_mov_b64 exec, s[46:47]
    buffer_load_dwordx4 v[248:251], v5, s[12:15], s98 offen offset:2048 sc1
    s_mov_b64 exec, s[48:49]
    buffer_load_dwordx4 v[252:255], v5, s[12:15], s98 offen offset:3072 sc1
    s_mov_b64 s[92:93], 0
    s_waitcnt vmcnt(0)
    s_mov_b64 exec, s[34:35]
    s_cbranch_execz Lsk_23
    v_xor_b32 v224, v48, v224
    v_xor_b32 v225, v49, v225
    v_xor_b32 v226, v50, v226
    v_xor_b32 v227, v51, v227
    ds_write_b128 v192, v[224:227] offset:0
    v_or3_b32 v8, v224, v225, v226
    v_or_b32 v8, v8, v227
    v_and_b32 v8, 0x10001, v8
    v_cmp_ne_u32 vcc, 0, v8
    s_nop 1
    s_wqm_b64 s[34:35], vcc
    s_or_b64 s[92:93], s[92:93], s[34:35]
Lsk_23:
    s_mov_b64 exec, s[36:37]
    s_cbranch_execz Lsk_24
    v_xor_b32 v228, v48, v228
    v_xor_b32 v229, v49, v229
    v_xor_b32 v230, v50, v230
    v_xor_b32 v231, v51, v231
    ds_write_b128 v193, v[228:231] offset:1024
    v_or3_b32 v8, v228, v229, v230
    v_or_b32 v8, v8, v231
    v_and_b32 v8, 0x10001, v8
    v_cmp_ne_u32 vcc, 0, v8
    s_nop 1
    s_wqm_b64 s[36:37], vcc
    s_or_b64 s[92:93], s[92:93], s[36:37]
Lsk_24:
    s_mov_b64 exec, s[38:39]
    s_cbranch_execz Lsk_25
    v_xor_b32 v232, v48, v232
    v_xor_b32 v233, v49, v233
    v_xor_b32 v234, v50, v234
    v_xor_b32 v235, v51, v235
    ds_write_b128 v194, v[232:235] offset:2048
    v_or3_b32 v8, v232, v233, v234
    v_or_b32 v8, v8, v235
    v_and_b32 v8, 0x10001, v8
    v_cmp_ne_u32 vcc, 0, v8
    s_nop 1
    s_wqm_b64 s[38:39], vcc
    s_or_b64 s[92:93], s[92:93], s[38:39]
Lsk_25:
    s_mov_b64 exec, s[40:41]
    s_cbranch_execz Lsk_26
    v_xor_b32 v236, v48, v236
    v_xor_b32 v237, v49, v237
    v_xor_b32 v238, v50, v238
    v_xor_b32 v239, v51, v239
    ds_write_b128 v195, v[236:239] offset:3072
    v_or3_b32 v8, v236, v237, v238
    v_or_b32 v8, v8, v239
    v_and_b32 v8, 0x10001, v8
    v_cmp_ne_u32 vcc, 0, v8
    s_nop 1
    s_wqm_b64 s[40:41], vcc
    s_or_b64 s[92:93], s[92:93], s[40:41]
Lsk_26:
    s_mov_b64 exec, s[42:43]
    s_cbranch_execz Lsk_27
    v_xor_b32 v240, v48, v240
    v_xor_b32 v241, v49, v241
    v_xor_b32 v242, v50, v242
    v_xor_b32 v243, v51, v243
    ds_write_b128 v196, v[240:243] offset:4096
    v_or3_b32 v8, v240, v241, v242
    v_or_b32 v8, v8, v243
    v_and_b32 v8, 0x10001, v8
    v_cmp_ne_u32 vcc, 0, v8
    s_nop 1
    s_wqm_b64 s[42:43], vcc
    s_or_b64 s[92:93], s[92:93], s[42:43]
Lsk_27:
    s_mov_b64 exec, s[44:45]
    s_cbranch_execz Lsk_28
    v_xor_b32 v244, v48, v244
    v_xor_b32 v245, v49, v245
    v_xor_b32 v246, v50, v246
    v_xor_b32 v247, v51, v247
    ds_write_b128 v197, v[244:247] offset:5120
    v_or3_b32 v8, v244, v245, v246
    v_or_b32 v8, v8, v247
    v_and_b32 v8, 0x10001, v8
    v_cmp_ne_u32 vcc, 0, v8
    s_nop 1
    s_wqm_b64 s[44:45], vcc
    s_or_b64 s[92:93], s[92:93], s[44:45]
Lsk_28:
    s_mov_b64 exec, s[46:47]
    s_cbranch_execz Lsk_29
    v_xor_b32 v248, v48, v248
    v_xor_b32 v249, v49, v249
    v_xor_b32 v250, v50, v250
    v_xor_b32 v251, v51, v251
    ds_write_b128 v198, v[248:251] offset:6144
    v_or3_b32 v8, v248, v249, v250
    v_or_b32 v8, v8, v251
    v_and_b32 v8, 0x10001, v8
    v_cmp_ne_u32 vcc, 0, v8
    s_nop 1
    s_wqm_b64 s[46:47], vcc
    s_or_b64 s[92:93], s[92:93], s[46:47]
Lsk_29:
    s_mov_b64 exec, s[48:49]
    s_cbranch_execz Lsk_30
    v_xor_b32 v252, v48, v252
    v_xor_b32 v253, v49, v253
    v_xor_b32 v254, v50, v254
    v_xor_b32 v255, v51, v255
    ds_write_b128 v199, v[252:255] offset:7168
    v_or3_b32 v8, v252, v253, v254
    v_or_b32 v8, v8, v255
    v_and_b32 v8, 0x10001, v8
    v_cmp_ne_u32 vcc, 0, v8
    s_nop 1
    s_wqm_b64 s[48:49], vcc
    s_or_b64 s[92:93], s[92:93], s[48:49]
Lsk_30:
    s_mov_b64 exec, -1
    s_waitcnt lgkmcnt(0)
    s_add_u32 s7, s7, 1
    s_cmp_eq_u64 s[92:93], 0
    s_cbranch_scc1 L_qok
    s_cmp_lt_u32 s7, 20000
    s_cbranch_scc1 Lsr_22
    s_branch L_qok
L_done:
L_exit:
    s_endpgm
.section .rodata,"a"
.p2align 6
.amdhsa_kernel concat_heads__sliding_block_cached__compressed_kv_cla__decode_kernel
  .amdhsa_next_free_vgpr 256
  .amdhsa_next_free_sgpr 102
  .amdhsa_accum_offset 256
  .amdhsa_group_segment_fixed_size 0
  .amdhsa_kernarg_size 112
  .amdhsa_user_sgpr_count 2
  .amdhsa_user_sgpr_kernarg_segment_ptr 1
  .amdhsa_system_sgpr_workgroup_id_x 1
.end_amdhsa_kernel
```
